```python
import torch

def _softmax(x, axis=-1):
    return torch.softmax(x, dim=axis)
def _gelu(x):
    return torch.nn.functional.gelu(x, approximate="tanh")
def _silu(x):
    return torch.nn.functional.silu(x)
def _sigmoid(x):
    return torch.sigmoid(x)
def _layernorm(x, axis=-1, eps=1e-5):
    m = x.mean(dim=axis, keepdim=True)
    v = x.var(dim=axis, keepdim=True, unbiased=False)
    return (x - m) / torch.sqrt(v + eps)
def _scatter_add(tgt, idx, src, axis=0):
    return tgt.clone().index_add_(axis, idx, src)
def _segment_sum(src, seg, n):
    out = torch.zeros((n,) + src.shape[1:], dtype=src.dtype)
    return out.index_add_(0, seg, src)
def _pad(x, pw):
    flat = tuple(v for pair in reversed(pw) for v in pair)
    return torch.nn.functional.pad(x, flat)

kernel_name = 'sequential_preLN__linear_kernel_hedgehog__dense_activation_gelu__prompt'

def setup_inputs():

    _w = (lambda a: (lambda t: t.to(torch.bfloat16) if t.is_floating_point() else t)(torch.as_tensor(a)))
    def _A_setup():
        B, S, D, H = 1, 2048, 512, 32
        Dh = D // H
        return {
            "x": _w((lambda *s: torch.randn(*s, dtype=torch.bfloat16) * 0.05)(B, S, D)),
            "wqkv": _w((lambda *s: torch.randn(*s, dtype=torch.bfloat16) * 0.2)(D, 3 * D)),
            "w_phi": _w((lambda *s: torch.randn(*s, dtype=torch.bfloat16) * 0.2)(H, Dh, Dh) * (Dh ** -0.5)),
            "wo": _w((lambda *s: torch.randn(*s, dtype=torch.bfloat16) * 0.05)(D, D)),
        }
    _A_in = _A_setup()

    def _B_setup():
        B, S, D, F = 1, 2048, 512, 1376
        return {
            "x": _w((lambda *s: torch.randn(*s, dtype=torch.bfloat16) * 0.05)(B, S, D)),
            "w1": _w((lambda *s: torch.randn(*s, dtype=torch.bfloat16) * 1.6)(D, F) * (D ** -0.5)),
            "b1": _w((lambda *s: torch.randn(*s, dtype=torch.bfloat16) * 0.1)(F) * 0.01),
            "w2": _w((lambda *s: torch.randn(*s, dtype=torch.bfloat16) * 0.1)(F, D) * (F ** -0.5)),
            "b2": _w((lambda *s: torch.randn(*s, dtype=torch.bfloat16) * 0.1)(D) * 0.01),
        }
    _B_in = _B_setup()

    return {
        "A_x": _A_in["x"],
        "A_wqkv": _A_in["wqkv"],
        "A_w_phi": _A_in["w_phi"],
        "A_wo": _A_in["wo"],
        "B_x": _B_in["x"],
        "B_w1": _B_in["w1"],
        "B_b1": _B_in["b1"],
        "B_w2": _B_in["w2"],
        "B_b2": _B_in["b2"],
    }

def reference(A_x, A_wqkv, A_w_phi, A_wo, B_x, B_w1, B_b1, B_w2, B_b2):
    def _A_ref(x, wqkv, w_phi, wo):
        B, S, D = x.shape
        H = 32; Dh = D // H
        qkv = (lambda x, *d: x.permute(*d))((x @ wqkv).reshape(B, S, 3, H, Dh), 2, 0, 3, 1, 4)
        q, k, v = qkv[0], qkv[1], qkv[2]
        pq = torch.einsum("bhsd,hdf->bhsf", q, w_phi)
        pk = torch.einsum("bhsd,hdf->bhsf", k, w_phi)
        phi_q = torch.concatenate([_softmax(pq, axis=-1), _softmax(-pq, axis=-1)], axis=-1)
        phi_k = torch.concatenate([_softmax(pk, axis=-1), _softmax(-pk, axis=-1)], axis=-1)
        kv = torch.einsum("bhsf,bhsd->bhfd", phi_k, v)
        z  = torch.einsum("bhsf->bhf", phi_k)
        num = torch.einsum("bhqf,bhfd->bhqd", phi_q, kv)
        den = torch.einsum("bhqf,bhf->bhq", phi_q, z)[..., None] + 1e-6
        o = num / den
        return (lambda x, *d: x.permute(*d))(o, 0, 2, 1, 3).reshape(B, S, D) @ wo

    def _B_ref(x, w1, b1, w2, b2):
        h = torch.einsum("bsd,df->bsf", x, w1) + b1
        h = _gelu(h)
        return torch.einsum("bsf,fd->bsd", h, w2) + b2

    x = A_x
    h = x + _A_ref(_layernorm(x, axis=-1), A_wqkv, A_w_phi, A_wo)
    h2 = h + _B_ref(_layernorm(h, axis=-1), B_w1, B_b1, B_w2, B_b2)
    return h2
```

```asm
; @launch grid=(256,1,1) block=(512,1,1) lds=163840
.amdgcn_target "amdgcn-amd-amdhsa--gfx950"
.text
.globl sequential_preLN__linear_kernel_hedgehog__dense_activation_gelu__prompt_kernel
.p2align 8
.type sequential_preLN__linear_kernel_hedgehog__dense_activation_gelu__prompt_kernel,@function
sequential_preLN__linear_kernel_hedgehog__dense_activation_gelu__prompt_kernel:
    s_cmp_ge_u32 s2, 256
    s_cbranch_scc1 L_END
    s_load_dwordx16 s[36:51], s[0:1], 0
    s_load_dwordx8 s[52:59], s[0:1], 64
    s_and_b32 s60, s2, 7
    s_lshr_b32 s61, s2, 3
    s_lshl_b32 s62, s60, 2
    s_lshr_b32 s70, s61, 3
    s_add_u32 s62, s62, s70
    s_and_b32 s63, s61, 7
    s_lshr_b32 s64, s62, 1
    s_and_b32 s65, s61, 15
    s_mov_b32 s23, s60
    s_mov_b32 s22, s70
    s_mov_b32 s20, s62
    s_mov_b32 s21, s63
    s_lshl_b32 s6, s70, 1
    s_add_u32 s6, s6, s63
    s_add_u32 s6, s6, s60
    s_lshl_b32 s71, s63, 2
    s_and_b32 s6, s6, 6
    s_lshl_b32 s3, s60, 5
    s_add_u32 s3, s3, s71
    v_lshrrev_b32 v1, 6, v0
    v_and_b32 v0, 63, v0
    v_readfirstlane_b32 s66, v1
    s_mov_b32 s5, 0x80000
    v_lshlrev_b32 v4, 4, v0
    s_cmp_lt_u32 s66, 4
    s_cbranch_scc1 L_COMPUTE
    s_sub_u32 s66, s66, 4
    s_cmp_eq_u32 s66, 2
    s_cbranch_scc1 L_TOUCH
    s_cmp_eq_u32 s66, 3
    s_cbranch_scc1 L_REG
    v_lshrrev_b32 v1, 3, v0
    v_and_b32 v2, 7, v0
    v_lshrrev_b32 v3, 4, v0
    v_xor_b32 v5, v2, v3
    v_lshlrev_b32 v5, 4, v5
    v_lshl_add_u32 v5, v1, 10, v5
    v_xor_b32 v6, 64, v5
    v_add_u32 v6, 7168, v6
    v_lshrrev_b32 v1, 3, v0
    v_and_b32 v2, 7, v0
    v_bfe_u32 v3, v0, 4, 1
    v_lshlrev_b32 v3, 2, v3
    v_xor_b32 v2, v2, v3
    v_lshlrev_b32 v2, 4, v2
    v_mul_u32_u24 v1, 3072, v1
    v_add_u32 v7, v1, v2
    v_add_u32 v8, 22528, v7
    v_add_u32 v9, 23552, v7
    s_lshl_b32 s74, s20, 16
    s_lshl_b32 s70, s66, 15
    s_add_u32 s74, s74, s70
    s_lshl_b32 s75, s21, 7
    s_mul_i32 s70, s66, 98304
    s_add_u32 s75, s75, s70
    s_lshl_b32 s76, s66, 12
    s_lshl_b32 s77, s66, 13
    s_add_u32 s77, s77, 65536
    s_waitcnt lgkmcnt(0)
    s_mov_b32 s8, s36
    s_mov_b32 s9, s37
    s_mov_b32 s10, 2097152
    s_mov_b32 s11, 0x20000
    s_mov_b32 s12, s38
    s_mov_b32 s13, s39
    s_mov_b32 s14, 1572864
    s_mov_b32 s15, 0x20000
    s_mov_b32 s32, 0
H_ISS:
    s_add_u32 s70, s6, s32
    s_and_b32 s70, s70, 7
    s_lshl_b32 s71, s70, 7
    s_add_u32 s71, s71, s74
    s_mul_i32 s72, s70, 196608
    s_add_u32 s72, s72, s75
    s_add_u32 s72, s72, 1024
    s_lshl_b32 s33, s32, 13
    s_add_u32 s33, s33, s76
    s_lshl_b32 s34, s32, 14
    s_add_u32 s34, s34, s77
    s_add_u32 m0, s33, 0
    s_nop 0
    buffer_load_dwordx4 v5, s[8:11], s71 offen lds
    buffer_load_dwordx4 v6, s[8:11], s71 offen offset:1024 lds
    s_add_u32 m0, s34, 0
    s_nop 0
    buffer_load_dwordx4 v7, s[12:15], s72 offen lds
    buffer_load_dwordx4 v7, s[12:15], s72 offen offset:1024 lds
    buffer_load_dwordx4 v8, s[12:15], s72 offen offset:2048 lds
    buffer_load_dwordx4 v8, s[12:15], s72 offen offset:3072 lds
    s_add_u32 m0, s33, 2048
    s_add_u32 s71, s71, 16384
    buffer_load_dwordx4 v5, s[8:11], s71 offen lds
    buffer_load_dwordx4 v6, s[8:11], s71 offen offset:1024 lds
    s_add_u32 m0, s34, 4096
    s_add_u32 s72, s72, 49152
    buffer_load_dwordx4 v7, s[12:15], s72 offen lds
    buffer_load_dwordx4 v7, s[12:15], s72 offen offset:1024 lds
    buffer_load_dwordx4 v8, s[12:15], s72 offen offset:2048 lds
    buffer_load_dwordx4 v8, s[12:15], s72 offen offset:3072 lds
    s_add_u32 s32, s32, 1
    s_cmp_lt_u32 s32, 2
    s_cbranch_scc1 H_ISS
    s_mov_b32 s24, s40
    s_mov_b32 s25, s41
    s_mov_b32 s26, 16384
    s_mov_b32 s27, 0x20000
    s_lshl_b32 s70, s21, 11
    s_lshl_b32 s71, s66, 10
    s_add_u32 s70, s70, s71
    s_lshl_b32 s71, s66, 14
    s_add_u32 m0, s71, 131072
    s_nop 0
    buffer_load_dwordx4 v4, s[24:27], s70 offen lds
    s_add_u32 m0, s71, 139264
    s_nop 0
    buffer_load_dwordx4 v4, s[24:27], s70 offen lds
    s_mov_b32 s44, s3
    s_add_u32 s70, s58, 4747264
    s_addc_u32 s71, s59, 0
    s_load_dword s69, s[70:71], 0
    v_mov_b32 v25, 156992
    s_cmp_eq_u32 s66, 1
    s_cselect_b32 s70, 5888, 0
    v_add_u32 v25, s70, v25
    v_mov_b32 v21, 0
    v_mov_b32 v10, 1
    v_mov_b32 v11, 156992
    v_mov_b32 v12, 162880
    v_cmp_eq_u32 vcc, 0, v0
    s_nop 1
    v_cndmask_b32 v11, v12, v11, vcc
    v_add_u32 v13, s77, v4
    v_add_u32 v14, 24576, v7
    s_waitcnt lgkmcnt(0)
    s_add_u32 s69, s69, 16
    s_and_b32 s69, s69, -16
    s_or_b32 s69, s69, 8
    s_waitcnt vmcnt(14)
    s_barrier
    s_add_u32 s70, s6, 2
    s_and_b32 s70, s70, 7
    s_lshl_b32 s71, s70, 7
    s_add_u32 s71, s71, s74
    s_mul_i32 s72, s70, 196608
    s_add_u32 s72, s72, s75
    s_add_u32 s72, s72, 1024
    s_add_u32 m0, s76, 16384
    s_nop 0
    buffer_load_dwordx4 v5, s[8:11], s71 offen lds
    buffer_load_dwordx4 v6, s[8:11], s71 offen offset:1024 lds
    s_add_u32 m0, s77, 32768
    s_nop 0
    buffer_load_dwordx4 v7, s[12:15], s72 offen lds
    buffer_load_dwordx4 v7, s[12:15], s72 offen offset:1024 lds
    buffer_load_dwordx4 v8, s[12:15], s72 offen offset:2048 lds
    buffer_load_dwordx4 v8, s[12:15], s72 offen offset:3072 lds
    s_add_u32 m0, s76, 18432
    s_add_u32 s71, s71, 16384
    buffer_load_dwordx4 v5, s[8:11], s71 offen lds
    buffer_load_dwordx4 v6, s[8:11], s71 offen offset:1024 lds
    s_add_u32 m0, s77, 36864
    s_add_u32 s72, s72, 49152
    buffer_load_dwordx4 v7, s[12:15], s72 offen lds
    buffer_load_dwordx4 v7, s[12:15], s72 offen offset:1024 lds
    buffer_load_dwordx4 v8, s[12:15], s72 offen offset:2048 lds
    buffer_load_dwordx4 v8, s[12:15], s72 offen offset:3072 lds
    s_waitcnt vmcnt(12)
    s_barrier
    s_add_u32 s70, s6, 3
    s_and_b32 s70, s70, 7
    s_lshl_b32 s71, s70, 7
    s_add_u32 s71, s71, s74
    s_mul_i32 s72, s70, 196608
    s_add_u32 s72, s72, s75
    s_add_u32 s72, s72, 1024
    s_add_u32 m0, s76, 24576
    s_nop 0
    buffer_load_dwordx4 v5, s[8:11], s71 offen lds
    buffer_load_dwordx4 v6, s[8:11], s71 offen offset:1024 lds
    s_add_u32 m0, s77, 49152
    s_nop 0
    buffer_load_dwordx4 v7, s[12:15], s72 offen lds
    buffer_load_dwordx4 v7, s[12:15], s72 offen offset:1024 lds
    buffer_load_dwordx4 v8, s[12:15], s72 offen offset:2048 lds
    buffer_load_dwordx4 v8, s[12:15], s72 offen offset:3072 lds
    s_add_u32 m0, s76, 26624
    s_add_u32 s71, s71, 16384
    buffer_load_dwordx4 v5, s[8:11], s71 offen lds
    buffer_load_dwordx4 v6, s[8:11], s71 offen offset:1024 lds
    s_add_u32 m0, s77, 53248
    s_add_u32 s72, s72, 49152
    buffer_load_dwordx4 v7, s[12:15], s72 offen lds
    buffer_load_dwordx4 v7, s[12:15], s72 offen offset:1024 lds
    buffer_load_dwordx4 v8, s[12:15], s72 offen offset:2048 lds
    buffer_load_dwordx4 v8, s[12:15], s72 offen offset:3072 lds
    s_waitcnt vmcnt(12)
    s_barrier
    s_add_u32 s70, s6, 4
    s_and_b32 s70, s70, 7
    s_lshl_b32 s71, s70, 7
    s_add_u32 s71, s71, s74
    s_mul_i32 s72, s70, 196608
    s_add_u32 s72, s72, s75
    s_add_u32 s72, s72, 1024
    s_add_u32 m0, s76, 32768
    s_nop 0
    buffer_load_dwordx4 v5, s[8:11], s71 offen lds
    buffer_load_dwordx4 v6, s[8:11], s71 offen offset:1024 lds
    s_add_u32 m0, s77, 0
    s_nop 0
    buffer_load_dwordx4 v7, s[12:15], s72 offen lds
    buffer_load_dwordx4 v7, s[12:15], s72 offen offset:1024 lds
    buffer_load_dwordx4 v8, s[12:15], s72 offen offset:2048 lds
    buffer_load_dwordx4 v8, s[12:15], s72 offen offset:3072 lds
    s_add_u32 m0, s76, 34816
    s_add_u32 s71, s71, 16384
    buffer_load_dwordx4 v5, s[8:11], s71 offen lds
    buffer_load_dwordx4 v6, s[8:11], s71 offen offset:1024 lds
    s_add_u32 m0, s77, 4096
    s_add_u32 s72, s72, 49152
    buffer_load_dwordx4 v7, s[12:15], s72 offen lds
    buffer_load_dwordx4 v7, s[12:15], s72 offen offset:1024 lds
    buffer_load_dwordx4 v8, s[12:15], s72 offen offset:2048 lds
    buffer_load_dwordx4 v8, s[12:15], s72 offen offset:3072 lds
    s_waitcnt vmcnt(12)
    s_barrier
    s_add_u32 s70, s6, 5
    s_and_b32 s70, s70, 7
    s_lshl_b32 s71, s70, 7
    s_add_u32 s71, s71, s74
    s_mul_i32 s72, s70, 196608
    s_add_u32 s72, s72, s75
    s_add_u32 s72, s72, 1024
    s_add_u32 m0, s76, 40960
    s_nop 0
    buffer_load_dwordx4 v5, s[8:11], s71 offen lds
    buffer_load_dwordx4 v6, s[8:11], s71 offen offset:1024 lds
    s_add_u32 m0, s77, 16384
    s_nop 0
    buffer_load_dwordx4 v7, s[12:15], s72 offen lds
    buffer_load_dwordx4 v7, s[12:15], s72 offen offset:1024 lds
    buffer_load_dwordx4 v8, s[12:15], s72 offen offset:2048 lds
    buffer_load_dwordx4 v8, s[12:15], s72 offen offset:3072 lds
    s_add_u32 m0, s76, 43008
    s_add_u32 s71, s71, 16384
    buffer_load_dwordx4 v5, s[8:11], s71 offen lds
    buffer_load_dwordx4 v6, s[8:11], s71 offen offset:1024 lds
    s_add_u32 m0, s77, 20480
    s_add_u32 s72, s72, 49152
    buffer_load_dwordx4 v7, s[12:15], s72 offen lds
    buffer_load_dwordx4 v7, s[12:15], s72 offen offset:1024 lds
    buffer_load_dwordx4 v8, s[12:15], s72 offen offset:2048 lds
    buffer_load_dwordx4 v8, s[12:15], s72 offen offset:3072 lds
    s_add_u32 s70, s6, 6
    s_and_b32 s70, s70, 7
    s_lshl_b32 s71, s70, 7
    s_add_u32 s71, s71, s74
    s_mul_i32 s72, s70, 196608
    s_add_u32 s72, s72, s75
    s_add_u32 s72, s72, 1024
    s_add_u32 m0, s76, 49152
    s_nop 0
    buffer_load_dwordx4 v5, s[8:11], s71 offen lds
    buffer_load_dwordx4 v6, s[8:11], s71 offen offset:1024 lds
    buffer_load_dwordx4 v[192:195], v7, s[12:15], s72 offen offset:0
    buffer_load_dwordx4 v[196:199], v7, s[12:15], s72 offen offset:1024
    buffer_load_dwordx4 v[200:203], v14, s[12:15], s72 offen offset:0
    buffer_load_dwordx4 v[204:207], v14, s[12:15], s72 offen offset:1024
    s_add_u32 m0, s76, 51200
    s_add_u32 s71, s71, 16384
    s_add_u32 s72, s72, 49152
    buffer_load_dwordx4 v5, s[8:11], s71 offen lds
    buffer_load_dwordx4 v6, s[8:11], s71 offen offset:1024 lds
    buffer_load_dwordx4 v[208:211], v7, s[12:15], s72 offen offset:0
    buffer_load_dwordx4 v[212:215], v7, s[12:15], s72 offen offset:1024
    buffer_load_dwordx4 v[216:219], v14, s[12:15], s72 offen offset:0
    buffer_load_dwordx4 v[220:223], v14, s[12:15], s72 offen offset:1024
    s_waitcnt vmcnt(24)
    s_waitcnt lgkmcnt(0)
    s_barrier
    s_add_u32 s70, s6, 7
    s_and_b32 s70, s70, 7
    s_lshl_b32 s71, s70, 7
    s_add_u32 s71, s71, s74
    s_mul_i32 s72, s70, 196608
    s_add_u32 s72, s72, s75
    s_add_u32 s72, s72, 1024
    s_add_u32 m0, s76, 57344
    s_nop 0
    buffer_load_dwordx4 v5, s[8:11], s71 offen lds
    buffer_load_dwordx4 v6, s[8:11], s71 offen offset:1024 lds
    buffer_load_dwordx4 v[224:227], v7, s[12:15], s72 offen offset:0
    buffer_load_dwordx4 v[228:231], v7, s[12:15], s72 offen offset:1024
    buffer_load_dwordx4 v[232:235], v14, s[12:15], s72 offen offset:0
    buffer_load_dwordx4 v[236:239], v14, s[12:15], s72 offen offset:1024
    s_add_u32 m0, s76, 59392
    s_add_u32 s71, s71, 16384
    s_add_u32 s72, s72, 49152
    buffer_load_dwordx4 v5, s[8:11], s71 offen lds
    buffer_load_dwordx4 v6, s[8:11], s71 offen offset:1024 lds
    buffer_load_dwordx4 v[240:243], v7, s[12:15], s72 offen offset:0
    buffer_load_dwordx4 v[244:247], v7, s[12:15], s72 offen offset:1024
    buffer_load_dwordx4 v[248:251], v14, s[12:15], s72 offen offset:0
    buffer_load_dwordx4 v[252:255], v14, s[12:15], s72 offen offset:1024
    s_waitcnt vmcnt(24)
    s_waitcnt lgkmcnt(0)
    s_barrier
    s_waitcnt vmcnt(12)
    ds_write_b128 v13, v[192:195] offset:32768
    ds_write_b128 v13, v[196:199] offset:33792
    ds_write_b128 v13, v[200:203] offset:34816
    ds_write_b128 v13, v[204:207] offset:35840
    ds_write_b128 v13, v[208:211] offset:36864
    ds_write_b128 v13, v[212:215] offset:37888
    ds_write_b128 v13, v[216:219] offset:38912
    ds_write_b128 v13, v[220:223] offset:39936
    s_waitcnt lgkmcnt(0)
    s_barrier
    s_waitcnt vmcnt(0)
    ds_write_b128 v13, v[224:227] offset:49152
    ds_write_b128 v13, v[228:231] offset:50176
    ds_write_b128 v13, v[232:235] offset:51200
    ds_write_b128 v13, v[236:239] offset:52224
    ds_write_b128 v13, v[240:243] offset:53248
    ds_write_b128 v13, v[244:247] offset:54272
    ds_write_b128 v13, v[248:251] offset:55296
    ds_write_b128 v13, v[252:255] offset:56320
    s_waitcnt lgkmcnt(0)
    s_barrier
    s_add_u32 s70, s6, 0
    s_and_b32 s70, s70, 7
    s_mul_i32 s72, s70, 196608
    s_add_u32 s72, s72, s75
    s_add_u32 m0, s76, 65536
    s_nop 0
    buffer_load_dwordx4 v7, s[12:15], s72 offen lds
    buffer_load_dwordx4 v9, s[12:15], s72 offen offset:1024 lds
    s_add_u32 m0, s76, 67584
    s_add_u32 s72, s72, 49152
    buffer_load_dwordx4 v7, s[12:15], s72 offen lds
    buffer_load_dwordx4 v9, s[12:15], s72 offen offset:1024 lds
    s_add_u32 s70, s6, 1
    s_and_b32 s70, s70, 7
    s_mul_i32 s72, s70, 196608
    s_add_u32 s72, s72, s75
    s_add_u32 m0, s76, 73728
    s_nop 0
    buffer_load_dwordx4 v7, s[12:15], s72 offen lds
    buffer_load_dwordx4 v9, s[12:15], s72 offen offset:1024 lds
    s_add_u32 m0, s76, 75776
    s_add_u32 s72, s72, 49152
    buffer_load_dwordx4 v7, s[12:15], s72 offen lds
    buffer_load_dwordx4 v9, s[12:15], s72 offen offset:1024 lds
    s_add_u32 s70, s6, 2
    s_and_b32 s70, s70, 7
    s_mul_i32 s72, s70, 196608
    s_add_u32 s72, s72, s75
    s_add_u32 m0, s76, 81920
    s_nop 0
    buffer_load_dwordx4 v7, s[12:15], s72 offen lds
    buffer_load_dwordx4 v9, s[12:15], s72 offen offset:1024 lds
    s_add_u32 m0, s76, 83968
    s_add_u32 s72, s72, 49152
    buffer_load_dwordx4 v7, s[12:15], s72 offen lds
    buffer_load_dwordx4 v9, s[12:15], s72 offen offset:1024 lds
    s_add_u32 s70, s6, 3
    s_and_b32 s70, s70, 7
    s_mul_i32 s72, s70, 196608
    s_add_u32 s72, s72, s75
    s_add_u32 m0, s76, 90112
    s_nop 0
    buffer_load_dwordx4 v7, s[12:15], s72 offen lds
    buffer_load_dwordx4 v9, s[12:15], s72 offen offset:1024 lds
    s_add_u32 m0, s76, 92160
    s_add_u32 s72, s72, 49152
    buffer_load_dwordx4 v7, s[12:15], s72 offen lds
    buffer_load_dwordx4 v9, s[12:15], s72 offen offset:1024 lds
CW1:
    ds_read_b32 v26, v25 offset:4
    s_sub_u32 s5, s5, 1
    s_cmp_lt_i32 s5, 0
    s_cbranch_scc1 CE2
    s_waitcnt lgkmcnt(0)
    v_readfirstlane_b32 s3, v26
    s_nop 0
    s_cmp_lt_u32 s3, 4
    s_cbranch_scc0 CE2
    s_sleep 1
    s_branch CW1
CE2:
    s_add_u32 s70, s6, 4
    s_and_b32 s70, s70, 7
    s_mul_i32 s72, s70, 196608
    s_add_u32 s72, s72, s75
    s_add_u32 m0, s76, 98304
    s_nop 0
    buffer_load_dwordx4 v7, s[12:15], s72 offen lds
    buffer_load_dwordx4 v9, s[12:15], s72 offen offset:1024 lds
    s_add_u32 m0, s76, 100352
    s_add_u32 s72, s72, 49152
    buffer_load_dwordx4 v7, s[12:15], s72 offen lds
    buffer_load_dwordx4 v9, s[12:15], s72 offen offset:1024 lds
    s_add_u32 s70, s6, 5
    s_and_b32 s70, s70, 7
    s_mul_i32 s72, s70, 196608
    s_add_u32 s72, s72, s75
    s_add_u32 m0, s76, 106496
    s_nop 0
    buffer_load_dwordx4 v7, s[12:15], s72 offen lds
    buffer_load_dwordx4 v9, s[12:15], s72 offen offset:1024 lds
    s_add_u32 m0, s76, 108544
    s_add_u32 s72, s72, 49152
    buffer_load_dwordx4 v7, s[12:15], s72 offen lds
    buffer_load_dwordx4 v9, s[12:15], s72 offen offset:1024 lds
    s_add_u32 s70, s6, 6
    s_and_b32 s70, s70, 7
    s_mul_i32 s72, s70, 196608
    s_add_u32 s72, s72, s75
    s_add_u32 m0, s76, 114688
    s_nop 0
    buffer_load_dwordx4 v7, s[12:15], s72 offen lds
    buffer_load_dwordx4 v9, s[12:15], s72 offen offset:1024 lds
    s_add_u32 m0, s76, 116736
    s_add_u32 s72, s72, 49152
    buffer_load_dwordx4 v7, s[12:15], s72 offen lds
    buffer_load_dwordx4 v9, s[12:15], s72 offen offset:1024 lds
    s_add_u32 s70, s6, 7
    s_and_b32 s70, s70, 7
    s_mul_i32 s72, s70, 196608
    s_add_u32 s72, s72, s75
    s_add_u32 m0, s76, 122880
    s_nop 0
    buffer_load_dwordx4 v7, s[12:15], s72 offen lds
    buffer_load_dwordx4 v9, s[12:15], s72 offen offset:1024 lds
    s_add_u32 m0, s76, 124928
    s_add_u32 s72, s72, 49152
    buffer_load_dwordx4 v7, s[12:15], s72 offen lds
    buffer_load_dwordx4 v9, s[12:15], s72 offen offset:1024 lds
    s_mov_b32 s16, s58
    s_mov_b32 s17, s59
    s_mov_b32 s18, 33554432
    s_mov_b32 s19, 0x20000
    s_mov_b32 s24, s42
    s_mov_b32 s25, s43
    s_mov_b32 s26, 524288
    s_mov_b32 s27, 0x20000
    v_lshrrev_b32 v1, 3, v0
    v_and_b32 v2, 7, v0
    v_bfe_u32 v3, v0, 4, 1
    v_lshlrev_b32 v3, 2, v3
    v_xor_b32 v2, v2, v3
    v_lshlrev_b32 v2, 4, v2
    v_mul_u32_u24 v1, 1024, v1
    v_add_u32 v16, v1, v2
    v_add_u32 v17, 7168, v16
    s_mov_b32 s28, s46
    s_mov_b32 s29, s47
    s_mov_b32 s30, 1409024
    s_mov_b32 s31, 0x20000
    s_cmp_eq_u32 s65, 14
    s_cselect_b32 s70, 4, 12
    s_cmp_eq_u32 s65, 15
    s_cselect_b32 s70, 0, s70
    v_mov_b32 v23, 0x40000000
    v_add_u32 v1, 0, v0
    v_mul_u32_u24 v2, 43691, v1
    v_lshrrev_b32 v2, 19, v2
    v_mul_u32_u24 v3, 12, v2
    v_sub_u32 v1, v1, v3
    v_mul_u32_u24 v2, 2752, v2
    v_lshl_add_u32 v18, v1, 4, v2
    v_cmp_gt_u32 vcc, s70, v1
    s_nop 1
    v_cndmask_b32 v18, v23, v18, vcc
    v_add_u32 v1, 64, v0
    v_mul_u32_u24 v2, 43691, v1
    v_lshrrev_b32 v2, 19, v2
    v_mul_u32_u24 v3, 12, v2
    v_sub_u32 v1, v1, v3
    v_mul_u32_u24 v2, 2752, v2
    v_lshl_add_u32 v19, v1, 4, v2
    v_cmp_gt_u32 vcc, s70, v1
    s_nop 1
    v_cndmask_b32 v19, v23, v19, vcc
    v_add_u32 v1, 128, v0
    v_mul_u32_u24 v2, 43691, v1
    v_lshrrev_b32 v2, 19, v2
    v_mul_u32_u24 v3, 12, v2
    v_sub_u32 v1, v1, v3
    v_mul_u32_u24 v2, 2752, v2
    v_lshl_add_u32 v20, v1, 4, v2
    v_cmp_gt_u32 vcc, s70, v1
    s_nop 1
    v_cndmask_b32 v20, v23, v20, vcc
    v_subrev_u32 v19, 1024, v19
    v_subrev_u32 v20, 2048, v20
    s_lshl_b32 s74, s66, 18
    s_lshl_b32 s70, s63, 7
    s_add_u32 s74, s74, s70
    s_lshl_b32 s76, s66, 15
    s_and_b32 s70, s63, 0
    s_lshl_b32 s70, s70, 16
    s_sub_u32 s75, s74, s70
    s_add_u32 s74, s74, s70
    s_waitcnt vmcnt(0)
    s_mov_b64 exec, 3
    ds_add_u32 v11, v10 offset:24
    s_mov_b64 exec, -1
CW3:
    ds_read_b32 v26, v25 offset:0
    s_sub_u32 s5, s5, 1
    s_cmp_lt_i32 s5, 0
    s_cbranch_scc1 CE4
    s_waitcnt lgkmcnt(0)
    v_readfirstlane_b32 s3, v26
    s_nop 0
    s_cmp_lt_u32 s3, 5
    s_cbranch_scc0 CE4
    s_sleep 2
    s_branch CW3
CE4:
    s_add_u32 m0, s76, 0
    s_add_u32 s70, s74, 0
    buffer_load_dwordx4 v16, s[24:27], s70 offen lds
    buffer_load_dwordx4 v17, s[24:27], s70 offen offset:1024 lds
    s_waitcnt vmcnt(12)
    s_add_u32 m0, s76, 2048
    s_add_u32 s70, s74, 16384
    buffer_load_dwordx4 v16, s[24:27], s70 offen lds
    buffer_load_dwordx4 v17, s[24:27], s70 offen offset:1024 lds
    s_waitcnt vmcnt(12)
    s_add_u32 m0, s76, 4096
    s_add_u32 s70, s74, 32768
    buffer_load_dwordx4 v16, s[24:27], s70 offen lds
    buffer_load_dwordx4 v17, s[24:27], s70 offen offset:1024 lds
    s_waitcnt vmcnt(12)
    s_add_u32 m0, s76, 6144
    s_add_u32 s70, s74, 49152
    buffer_load_dwordx4 v16, s[24:27], s70 offen lds
    buffer_load_dwordx4 v17, s[24:27], s70 offen offset:1024 lds
    s_waitcnt vmcnt(12)
    s_add_u32 m0, s76, 8192
    s_add_u32 s70, s75, 65536
    buffer_load_dwordx4 v16, s[24:27], s70 offen lds
    buffer_load_dwordx4 v17, s[24:27], s70 offen offset:1024 lds
    s_waitcnt vmcnt(12)
    s_add_u32 m0, s76, 10240
    s_add_u32 s70, s75, 81920
    buffer_load_dwordx4 v16, s[24:27], s70 offen lds
    buffer_load_dwordx4 v17, s[24:27], s70 offen offset:1024 lds
    s_waitcnt vmcnt(12)
    s_add_u32 m0, s76, 12288
    s_add_u32 s70, s75, 98304
    buffer_load_dwordx4 v16, s[24:27], s70 offen lds
    buffer_load_dwordx4 v17, s[24:27], s70 offen offset:1024 lds
    s_waitcnt vmcnt(12)
    s_add_u32 m0, s76, 14336
    s_add_u32 s70, s75, 114688
    buffer_load_dwordx4 v16, s[24:27], s70 offen lds
    buffer_load_dwordx4 v17, s[24:27], s70 offen offset:1024 lds
    s_waitcnt vmcnt(12)
    s_add_u32 m0, s76, 16384
    s_add_u32 s70, s74, 131072
    buffer_load_dwordx4 v16, s[24:27], s70 offen lds
    buffer_load_dwordx4 v17, s[24:27], s70 offen offset:1024 lds
    s_waitcnt vmcnt(12)
    s_add_u32 m0, s76, 18432
    s_add_u32 s70, s74, 147456
    buffer_load_dwordx4 v16, s[24:27], s70 offen lds
    buffer_load_dwordx4 v17, s[24:27], s70 offen offset:1024 lds
    s_waitcnt vmcnt(12)
    s_add_u32 m0, s76, 20480
    s_add_u32 s70, s74, 163840
    buffer_load_dwordx4 v16, s[24:27], s70 offen lds
    buffer_load_dwordx4 v17, s[24:27], s70 offen offset:1024 lds
    s_waitcnt vmcnt(12)
    s_add_u32 m0, s76, 22528
    s_add_u32 s70, s74, 180224
    buffer_load_dwordx4 v16, s[24:27], s70 offen lds
    buffer_load_dwordx4 v17, s[24:27], s70 offen offset:1024 lds
    s_waitcnt vmcnt(12)
    s_add_u32 m0, s76, 24576
    s_add_u32 s70, s75, 196608
    buffer_load_dwordx4 v16, s[24:27], s70 offen lds
    buffer_load_dwordx4 v17, s[24:27], s70 offen offset:1024 lds
    s_waitcnt vmcnt(12)
    s_add_u32 m0, s76, 26624
    s_add_u32 s70, s75, 212992
    buffer_load_dwordx4 v16, s[24:27], s70 offen lds
    buffer_load_dwordx4 v17, s[24:27], s70 offen offset:1024 lds
    s_waitcnt vmcnt(12)
    s_add_u32 m0, s76, 28672
    s_add_u32 s70, s75, 229376
    buffer_load_dwordx4 v16, s[24:27], s70 offen lds
    buffer_load_dwordx4 v17, s[24:27], s70 offen offset:1024 lds
    s_waitcnt vmcnt(12)
    s_add_u32 m0, s76, 30720
    s_add_u32 s70, s75, 245760
    buffer_load_dwordx4 v16, s[24:27], s70 offen lds
    buffer_load_dwordx4 v17, s[24:27], s70 offen offset:1024 lds
    s_waitcnt vmcnt(12)
    s_lshl_b32 s71, s2, 4
    s_lshl_b32 s72, s66, 3
    s_add_u32 s71, s71, s72
    s_add_u32 s71, s71, 4722688
    s_mul_i32 s74, s66, 88064
    s_mul_i32 s70, s65, 192
    s_add_u32 s74, s74, s70
    s_mul_i32 s75, s66, 6144
    s_add_u32 s75, s75, 65536
    s_and_b32 s76, s65, 0
    s_lshl_b32 s76, s76, 1
    v_lshrrev_b32 v2, 5, v0
    v_bfe_u32 v3, v0, 2, 2
    v_lshl_add_u32 v3, v2, 2, v3
    v_mul_u32_u24 v28, 192, v3
    v_bfe_u32 v3, v0, 4, 1
    v_lshl_add_u32 v28, v3, 5, v28
    v_and_b32 v3, 3, v0
    v_lshl_add_u32 v28, v3, 3, v28
    v_add_u32 v28, s75, v28
    v_add_u32 v29, 49152, v28
    v_lshrrev_b32 v3, 2, v0
    v_xor_b32 v3, v3, v0
    v_and_b32 v3, 4, v3
    v_and_b32 v2, 3, v0
    v_or_b32 v3, v3, v2
    v_cmp_eq_u32 vcc, 0, v3
    v_mov_b32 v2, 0x3f803f80
    s_nop 0
    v_cndmask_b32 v32, 0, v2, vcc
    v_cndmask_b32 v33, 0, v2, vcc
    v_cndmask_b32 v34, 0, v2, vcc
    v_cndmask_b32 v35, 0, v2, vcc
    s_add_u32 s70, s76, 0
    s_and_b32 s70, s70, 7
    s_mul_i32 s70, s70, 176128
    s_add_u32 s70, s70, s74
    s_add_u32 m0, s75, 0
    s_nop 0
    buffer_load_dwordx4 v18, s[28:31], s70 offen lds
    buffer_load_dwordx4 v19, s[28:31], s70 offen offset:1024 lds
    buffer_load_dwordx4 v20, s[28:31], s70 offen offset:2048 lds
    s_waitcnt vmcnt(12)
    s_add_u32 m0, s75, 3072
    s_add_u32 s70, s70, 44032
    buffer_load_dwordx4 v18, s[28:31], s70 offen lds
    buffer_load_dwordx4 v19, s[28:31], s70 offen offset:1024 lds
    buffer_load_dwordx4 v20, s[28:31], s70 offen offset:2048 lds
    s_waitcnt vmcnt(12)
    s_add_u32 s70, s76, 1
    s_and_b32 s70, s70, 7
    s_mul_i32 s70, s70, 176128
    s_add_u32 s70, s70, s74
    s_add_u32 m0, s75, 12288
    s_nop 0
    buffer_load_dwordx4 v18, s[28:31], s70 offen lds
    buffer_load_dwordx4 v19, s[28:31], s70 offen offset:1024 lds
    buffer_load_dwordx4 v20, s[28:31], s70 offen offset:2048 lds
    s_waitcnt vmcnt(12)
    s_add_u32 m0, s75, 15360
    s_add_u32 s70, s70, 44032
    buffer_load_dwordx4 v18, s[28:31], s70 offen lds
    buffer_load_dwordx4 v19, s[28:31], s70 offen offset:1024 lds
    buffer_load_dwordx4 v20, s[28:31], s70 offen offset:2048 lds
    s_waitcnt vmcnt(12)
    v_mov_b32 v22, s69
    v_mov_b32 v23, s69
    s_waitcnt vmcnt(12)
    s_mov_b64 exec, 1
    buffer_store_dwordx2 v[22:23], v21, s[16:19], s71 offen
    s_mov_b64 exec, -1
CW5:
    ds_read_b32 v26, v25 offset:8
    s_sub_u32 s5, s5, 1
    s_cmp_lt_i32 s5, 0
    s_cbranch_scc1 CE6
    s_waitcnt lgkmcnt(0)
    v_readfirstlane_b32 s3, v26
    s_nop 0
    s_cmp_lt_u32 s3, 0
    s_cbranch_scc0 CE6
    s_sleep 2
    s_branch CW5
CE6:
    s_add_u32 s70, s76, 2
    s_and_b32 s70, s70, 7
    s_mul_i32 s70, s70, 176128
    s_add_u32 s70, s70, s74
    s_add_u32 m0, s75, 24576
    s_nop 0
    buffer_load_dwordx4 v18, s[28:31], s70 offen lds
    buffer_load_dwordx4 v19, s[28:31], s70 offen offset:1024 lds
    buffer_load_dwordx4 v20, s[28:31], s70 offen offset:2048 lds
    s_waitcnt vmcnt(12)
    s_add_u32 m0, s75, 27648
    s_add_u32 s70, s70, 44032
    buffer_load_dwordx4 v18, s[28:31], s70 offen lds
    buffer_load_dwordx4 v19, s[28:31], s70 offen offset:1024 lds
    buffer_load_dwordx4 v20, s[28:31], s70 offen offset:2048 lds
    s_waitcnt vmcnt(12)
    ds_read_b64_tr_b16 v[48:49], v28 offset:0
    ds_read_b64_tr_b16 v[50:51], v28 offset:1536
    ds_read_b64_tr_b16 v[52:53], v28 offset:64
    ds_read_b64_tr_b16 v[54:55], v28 offset:1600
    ds_read_b64_tr_b16 v[56:57], v28 offset:128
    ds_read_b64_tr_b16 v[58:59], v28 offset:1664
    ds_read_b64_tr_b16 v[60:61], v28 offset:3072
    ds_read_b64_tr_b16 v[62:63], v28 offset:4608
    ds_read_b64_tr_b16 v[64:65], v28 offset:3136
    ds_read_b64_tr_b16 v[66:67], v28 offset:4672
    ds_read_b64_tr_b16 v[68:69], v28 offset:3200
    ds_read_b64_tr_b16 v[70:71], v28 offset:4736
    s_waitcnt lgkmcnt(0)
    v_mfma_f32_16x16x32_bf16 v[36:39], v[32:35], v[48:51], 0
    v_mfma_f32_16x16x32_bf16 v[40:43], v[32:35], v[52:55], 0
    v_mfma_f32_16x16x32_bf16 v[44:47], v[32:35], v[56:59], 0
    v_mfma_f32_16x16x32_bf16 v[36:39], v[32:35], v[60:63], v[36:39]
    v_mfma_f32_16x16x32_bf16 v[40:43], v[32:35], v[64:67], v[40:43]
    v_mfma_f32_16x16x32_bf16 v[44:47], v[32:35], v[68:71], v[44:47]
    s_add_u32 s70, s76, 3
    s_and_b32 s70, s70, 7
    s_mul_i32 s70, s70, 176128
    s_add_u32 s70, s70, s74
    s_add_u32 m0, s75, 36864
    s_nop 0
    buffer_load_dwordx4 v18, s[28:31], s70 offen lds
    buffer_load_dwordx4 v19, s[28:31], s70 offen offset:1024 lds
    buffer_load_dwordx4 v20, s[28:31], s70 offen offset:2048 lds
    s_waitcnt vmcnt(12)
    s_add_u32 m0, s75, 39936
    s_add_u32 s70, s70, 44032
    buffer_load_dwordx4 v18, s[28:31], s70 offen lds
    buffer_load_dwordx4 v19, s[28:31], s70 offen offset:1024 lds
    buffer_load_dwordx4 v20, s[28:31], s70 offen offset:2048 lds
    s_waitcnt vmcnt(12)
    ds_read_b64_tr_b16 v[48:49], v28 offset:12288
    ds_read_b64_tr_b16 v[50:51], v28 offset:13824
    ds_read_b64_tr_b16 v[52:53], v28 offset:12352
    ds_read_b64_tr_b16 v[54:55], v28 offset:13888
    ds_read_b64_tr_b16 v[56:57], v28 offset:12416
    ds_read_b64_tr_b16 v[58:59], v28 offset:13952
    ds_read_b64_tr_b16 v[60:61], v28 offset:15360
    ds_read_b64_tr_b16 v[62:63], v28 offset:16896
    ds_read_b64_tr_b16 v[64:65], v28 offset:15424
    ds_read_b64_tr_b16 v[66:67], v28 offset:16960
    ds_read_b64_tr_b16 v[68:69], v28 offset:15488
    ds_read_b64_tr_b16 v[70:71], v28 offset:17024
    s_waitcnt lgkmcnt(0)
    v_mfma_f32_16x16x32_bf16 v[36:39], v[32:35], v[48:51], v[36:39]
    v_mfma_f32_16x16x32_bf16 v[40:43], v[32:35], v[52:55], v[40:43]
    v_mfma_f32_16x16x32_bf16 v[44:47], v[32:35], v[56:59], v[44:47]
    v_mfma_f32_16x16x32_bf16 v[36:39], v[32:35], v[60:63], v[36:39]
    v_mfma_f32_16x16x32_bf16 v[40:43], v[32:35], v[64:67], v[40:43]
    v_mfma_f32_16x16x32_bf16 v[44:47], v[32:35], v[68:71], v[44:47]
    s_add_u32 s70, s76, 4
    s_and_b32 s70, s70, 7
    s_mul_i32 s70, s70, 176128
    s_add_u32 s70, s70, s74
    s_add_u32 m0, s75, 49152
    s_nop 0
    buffer_load_dwordx4 v18, s[28:31], s70 offen lds
    buffer_load_dwordx4 v19, s[28:31], s70 offen offset:1024 lds
    buffer_load_dwordx4 v20, s[28:31], s70 offen offset:2048 lds
    s_waitcnt vmcnt(12)
    s_add_u32 m0, s75, 52224
    s_add_u32 s70, s70, 44032
    buffer_load_dwordx4 v18, s[28:31], s70 offen lds
    buffer_load_dwordx4 v19, s[28:31], s70 offen offset:1024 lds
    buffer_load_dwordx4 v20, s[28:31], s70 offen offset:2048 lds
    s_waitcnt vmcnt(12)
    ds_read_b64_tr_b16 v[48:49], v28 offset:24576
    ds_read_b64_tr_b16 v[50:51], v28 offset:26112
    ds_read_b64_tr_b16 v[52:53], v28 offset:24640
    ds_read_b64_tr_b16 v[54:55], v28 offset:26176
    ds_read_b64_tr_b16 v[56:57], v28 offset:24704
    ds_read_b64_tr_b16 v[58:59], v28 offset:26240
    ds_read_b64_tr_b16 v[60:61], v28 offset:27648
    ds_read_b64_tr_b16 v[62:63], v28 offset:29184
    ds_read_b64_tr_b16 v[64:65], v28 offset:27712
    ds_read_b64_tr_b16 v[66:67], v28 offset:29248
    ds_read_b64_tr_b16 v[68:69], v28 offset:27776
    ds_read_b64_tr_b16 v[70:71], v28 offset:29312
    s_waitcnt lgkmcnt(0)
    v_mfma_f32_16x16x32_bf16 v[36:39], v[32:35], v[48:51], v[36:39]
    v_mfma_f32_16x16x32_bf16 v[40:43], v[32:35], v[52:55], v[40:43]
    v_mfma_f32_16x16x32_bf16 v[44:47], v[32:35], v[56:59], v[44:47]
    v_mfma_f32_16x16x32_bf16 v[36:39], v[32:35], v[60:63], v[36:39]
    v_mfma_f32_16x16x32_bf16 v[40:43], v[32:35], v[64:67], v[40:43]
    v_mfma_f32_16x16x32_bf16 v[44:47], v[32:35], v[68:71], v[44:47]
    s_add_u32 s70, s76, 5
    s_and_b32 s70, s70, 7
    s_mul_i32 s70, s70, 176128
    s_add_u32 s70, s70, s74
    s_add_u32 m0, s75, 61440
    s_nop 0
    buffer_load_dwordx4 v18, s[28:31], s70 offen lds
    buffer_load_dwordx4 v19, s[28:31], s70 offen offset:1024 lds
    buffer_load_dwordx4 v20, s[28:31], s70 offen offset:2048 lds
    s_waitcnt vmcnt(12)
    s_add_u32 m0, s75, 64512
    s_add_u32 s70, s70, 44032
    buffer_load_dwordx4 v18, s[28:31], s70 offen lds
    buffer_load_dwordx4 v19, s[28:31], s70 offen offset:1024 lds
    buffer_load_dwordx4 v20, s[28:31], s70 offen offset:2048 lds
    s_waitcnt vmcnt(12)
    ds_read_b64_tr_b16 v[48:49], v28 offset:36864
    ds_read_b64_tr_b16 v[50:51], v28 offset:38400
    ds_read_b64_tr_b16 v[52:53], v28 offset:36928
    ds_read_b64_tr_b16 v[54:55], v28 offset:38464
    ds_read_b64_tr_b16 v[56:57], v28 offset:36992
    ds_read_b64_tr_b16 v[58:59], v28 offset:38528
    ds_read_b64_tr_b16 v[60:61], v28 offset:39936
    ds_read_b64_tr_b16 v[62:63], v28 offset:41472
    ds_read_b64_tr_b16 v[64:65], v28 offset:40000
    ds_read_b64_tr_b16 v[66:67], v28 offset:41536
    ds_read_b64_tr_b16 v[68:69], v28 offset:40064
    ds_read_b64_tr_b16 v[70:71], v28 offset:41600
    s_waitcnt lgkmcnt(0)
    v_mfma_f32_16x16x32_bf16 v[36:39], v[32:35], v[48:51], v[36:39]
    v_mfma_f32_16x16x32_bf16 v[40:43], v[32:35], v[52:55], v[40:43]
    v_mfma_f32_16x16x32_bf16 v[44:47], v[32:35], v[56:59], v[44:47]
    v_mfma_f32_16x16x32_bf16 v[36:39], v[32:35], v[60:63], v[36:39]
    v_mfma_f32_16x16x32_bf16 v[40:43], v[32:35], v[64:67], v[40:43]
    v_mfma_f32_16x16x32_bf16 v[44:47], v[32:35], v[68:71], v[44:47]
    s_add_u32 s70, s76, 6
    s_and_b32 s70, s70, 7
    s_mul_i32 s70, s70, 176128
    s_add_u32 s70, s70, s74
    s_add_u32 m0, s75, 73728
    s_nop 0
    buffer_load_dwordx4 v18, s[28:31], s70 offen lds
    buffer_load_dwordx4 v19, s[28:31], s70 offen offset:1024 lds
    buffer_load_dwordx4 v20, s[28:31], s70 offen offset:2048 lds
    s_waitcnt vmcnt(12)
    s_add_u32 m0, s75, 76800
    s_add_u32 s70, s70, 44032
    buffer_load_dwordx4 v18, s[28:31], s70 offen lds
    buffer_load_dwordx4 v19, s[28:31], s70 offen offset:1024 lds
    buffer_load_dwordx4 v20, s[28:31], s70 offen offset:2048 lds
    s_waitcnt vmcnt(12)
    ds_read_b64_tr_b16 v[48:49], v29 offset:0
    ds_read_b64_tr_b16 v[50:51], v29 offset:1536
    ds_read_b64_tr_b16 v[52:53], v29 offset:64
    ds_read_b64_tr_b16 v[54:55], v29 offset:1600
    ds_read_b64_tr_b16 v[56:57], v29 offset:128
    ds_read_b64_tr_b16 v[58:59], v29 offset:1664
    ds_read_b64_tr_b16 v[60:61], v29 offset:3072
    ds_read_b64_tr_b16 v[62:63], v29 offset:4608
    ds_read_b64_tr_b16 v[64:65], v29 offset:3136
    ds_read_b64_tr_b16 v[66:67], v29 offset:4672
    ds_read_b64_tr_b16 v[68:69], v29 offset:3200
    ds_read_b64_tr_b16 v[70:71], v29 offset:4736
    s_waitcnt lgkmcnt(0)
    v_mfma_f32_16x16x32_bf16 v[36:39], v[32:35], v[48:51], v[36:39]
    v_mfma_f32_16x16x32_bf16 v[40:43], v[32:35], v[52:55], v[40:43]
    v_mfma_f32_16x16x32_bf16 v[44:47], v[32:35], v[56:59], v[44:47]
    v_mfma_f32_16x16x32_bf16 v[36:39], v[32:35], v[60:63], v[36:39]
    v_mfma_f32_16x16x32_bf16 v[40:43], v[32:35], v[64:67], v[40:43]
    v_mfma_f32_16x16x32_bf16 v[44:47], v[32:35], v[68:71], v[44:47]
    s_waitcnt vmcnt(6)
    s_mov_b64 exec, 3
    ds_add_u32 v11, v10 offset:32
    s_mov_b64 exec, -1
CW7:
    ds_read_b32 v26, v25 offset:28
    s_sub_u32 s5, s5, 1
    s_cmp_lt_i32 s5, 0
    s_cbranch_scc1 CE8
    s_waitcnt lgkmcnt(0)
    v_readfirstlane_b32 s3, v26
    s_nop 0
    s_cmp_lt_u32 s3, 4
    s_cbranch_scc0 CE8
    s_sleep 2
    s_branch CW7
CE8:
    s_waitcnt vmcnt(6)
    ds_read_b64_tr_b16 v[48:49], v29 offset:12288
    ds_read_b64_tr_b16 v[50:51], v29 offset:13824
    ds_read_b64_tr_b16 v[52:53], v29 offset:12352
    ds_read_b64_tr_b16 v[54:55], v29 offset:13888
    ds_read_b64_tr_b16 v[56:57], v29 offset:12416
    ds_read_b64_tr_b16 v[58:59], v29 offset:13952
    ds_read_b64_tr_b16 v[60:61], v29 offset:15360
    ds_read_b64_tr_b16 v[62:63], v29 offset:16896
    ds_read_b64_tr_b16 v[64:65], v29 offset:15424
    ds_read_b64_tr_b16 v[66:67], v29 offset:16960
    ds_read_b64_tr_b16 v[68:69], v29 offset:15488
    ds_read_b64_tr_b16 v[70:71], v29 offset:17024
    s_waitcnt lgkmcnt(0)
    v_mfma_f32_16x16x32_bf16 v[36:39], v[32:35], v[48:51], v[36:39]
    v_mfma_f32_16x16x32_bf16 v[40:43], v[32:35], v[52:55], v[40:43]
    v_mfma_f32_16x16x32_bf16 v[44:47], v[32:35], v[56:59], v[44:47]
    v_mfma_f32_16x16x32_bf16 v[36:39], v[32:35], v[60:63], v[36:39]
    v_mfma_f32_16x16x32_bf16 v[40:43], v[32:35], v[64:67], v[40:43]
    v_mfma_f32_16x16x32_bf16 v[44:47], v[32:35], v[68:71], v[44:47]
    s_add_u32 s70, s76, 7
    s_and_b32 s70, s70, 7
    s_mul_i32 s70, s70, 176128
    s_add_u32 s70, s70, s74
    s_add_u32 m0, s75, 86016
    s_nop 0
    buffer_load_dwordx4 v18, s[28:31], s70 offen lds
    buffer_load_dwordx4 v19, s[28:31], s70 offen offset:1024 lds
    buffer_load_dwordx4 v20, s[28:31], s70 offen offset:2048 lds
    s_waitcnt vmcnt(12)
    s_add_u32 m0, s75, 89088
    s_add_u32 s70, s70, 44032
    buffer_load_dwordx4 v18, s[28:31], s70 offen lds
    buffer_load_dwordx4 v19, s[28:31], s70 offen offset:1024 lds
    buffer_load_dwordx4 v20, s[28:31], s70 offen offset:2048 lds
    s_waitcnt vmcnt(12)
    s_waitcnt vmcnt(6)
    ds_read_b64_tr_b16 v[48:49], v29 offset:24576
    ds_read_b64_tr_b16 v[50:51], v29 offset:26112
    ds_read_b64_tr_b16 v[52:53], v29 offset:24640
    ds_read_b64_tr_b16 v[54:55], v29 offset:26176
    ds_read_b64_tr_b16 v[56:57], v29 offset:24704
    ds_read_b64_tr_b16 v[58:59], v29 offset:26240
    ds_read_b64_tr_b16 v[60:61], v29 offset:27648
    ds_read_b64_tr_b16 v[62:63], v29 offset:29184
    ds_read_b64_tr_b16 v[64:65], v29 offset:27712
    ds_read_b64_tr_b16 v[66:67], v29 offset:29248
    ds_read_b64_tr_b16 v[68:69], v29 offset:27776
    ds_read_b64_tr_b16 v[70:71], v29 offset:29312
    s_waitcnt lgkmcnt(0)
    v_mfma_f32_16x16x32_bf16 v[36:39], v[32:35], v[48:51], v[36:39]
    v_mfma_f32_16x16x32_bf16 v[40:43], v[32:35], v[52:55], v[40:43]
    v_mfma_f32_16x16x32_bf16 v[44:47], v[32:35], v[56:59], v[44:47]
    v_mfma_f32_16x16x32_bf16 v[36:39], v[32:35], v[60:63], v[36:39]
    v_mfma_f32_16x16x32_bf16 v[40:43], v[32:35], v[64:67], v[40:43]
    v_mfma_f32_16x16x32_bf16 v[44:47], v[32:35], v[68:71], v[44:47]
    s_waitcnt vmcnt(0)
    ds_read_b64_tr_b16 v[48:49], v29 offset:36864
    ds_read_b64_tr_b16 v[50:51], v29 offset:38400
    ds_read_b64_tr_b16 v[52:53], v29 offset:36928
    ds_read_b64_tr_b16 v[54:55], v29 offset:38464
    ds_read_b64_tr_b16 v[56:57], v29 offset:36992
    ds_read_b64_tr_b16 v[58:59], v29 offset:38528
    ds_read_b64_tr_b16 v[60:61], v29 offset:39936
    ds_read_b64_tr_b16 v[62:63], v29 offset:41472
    ds_read_b64_tr_b16 v[64:65], v29 offset:40000
    ds_read_b64_tr_b16 v[66:67], v29 offset:41536
    ds_read_b64_tr_b16 v[68:69], v29 offset:40064
    ds_read_b64_tr_b16 v[70:71], v29 offset:41600
    s_waitcnt lgkmcnt(0)
    v_mfma_f32_16x16x32_bf16 v[36:39], v[32:35], v[48:51], v[36:39]
    v_mfma_f32_16x16x32_bf16 v[40:43], v[32:35], v[52:55], v[40:43]
    v_mfma_f32_16x16x32_bf16 v[44:47], v[32:35], v[56:59], v[44:47]
    v_mfma_f32_16x16x32_bf16 v[36:39], v[32:35], v[60:63], v[36:39]
    v_mfma_f32_16x16x32_bf16 v[40:43], v[32:35], v[64:67], v[40:43]
    v_mfma_f32_16x16x32_bf16 v[44:47], v[32:35], v[68:71], v[44:47]
    s_lshl_b32 s70, s66, 14
    v_lshl_add_u32 v28, v0, 2, s70
    s_mov_b32 s28, s50
    s_mov_b32 s29, s51
    s_mov_b32 s30, 1409024
    s_mov_b32 s31, 0x20000
    s_mul_i32 s74, s66, 720896
    s_lshl_b32 s70, s63, 7
    s_add_u32 s74, s74, s70
    s_mul_i32 s6, s63, 0
    s_waitcnt vmcnt(0)
    s_barrier
    ds_write_b32 v28, v36 offset:0
    ds_write_b32 v28, v40 offset:256
    ds_write_b32 v28, v44 offset:512
    s_waitcnt lgkmcnt(0)
    s_barrier
    s_barrier
    s_barrier
    v_lshlrev_b32 v24, 7, v0
    s_mul_i32 s70, s66, 720896
    s_mul_i32 s71, s61, 5120
    s_add_u32 s70, s70, s71
    s_add_u32 s70, s70, 196608
    s_mov_b64 exec, -1
    s_mov_b32 exec_hi, 0xff
    buffer_load_dword v250, v24, s[28:31], s70 offen
    s_add_u32 s70, s70, 360448
    buffer_load_dword v250, v24, s[28:31], s70 offen
    s_mov_b64 exec, -1
    s_lshl_b32 s75, s66, 15
    s_and_b32 s76, s62, 3
    s_mul_i32 s76, s76, 2
    s_add_u32 s76, s76, 0
    s_add_u32 s72, s76, s6
    s_cmp_ge_u32 s72, 22
    s_cselect_b32 s3, 22, 0
    s_sub_u32 s72, s72, s3
    s_lshl_b32 s72, s72, 14
    s_add_u32 s72, s72, s74
    s_lshl_b32 s71, s76, 11
    s_add_u32 s71, s71, s75
    s_add_u32 m0, s71, 0
    s_nop 0
    buffer_load_dwordx4 v16, s[28:31], s72 offen lds
    buffer_load_dwordx4 v17, s[28:31], s72 offen offset:1024 lds
    s_add_u32 m0, s71, 16384
    s_add_u32 s72, s72, 360448
    buffer_load_dwordx4 v16, s[28:31], s72 offen lds
    buffer_load_dwordx4 v17, s[28:31], s72 offen offset:1024 lds
    s_add_u32 s76, s76, 1
    s_cmp_eq_u32 s76, 8
    s_cselect_b32 s76, 0, s76
    s_add_u32 s72, s76, s6
    s_cmp_ge_u32 s72, 22
    s_cselect_b32 s3, 22, 0
    s_sub_u32 s72, s72, s3
    s_lshl_b32 s72, s72, 14
    s_add_u32 s72, s72, s74
    s_lshl_b32 s71, s76, 11
    s_add_u32 s71, s71, s75
    s_add_u32 m0, s71, 0
    s_nop 0
    buffer_load_dwordx4 v16, s[28:31], s72 offen lds
    buffer_load_dwordx4 v17, s[28:31], s72 offen offset:1024 lds
    s_add_u32 m0, s71, 16384
    s_add_u32 s72, s72, 360448
    buffer_load_dwordx4 v16, s[28:31], s72 offen lds
    buffer_load_dwordx4 v17, s[28:31], s72 offen offset:1024 lds
    s_add_u32 s76, s76, 1
    s_cmp_eq_u32 s76, 8
    s_cselect_b32 s76, 0, s76
    s_add_u32 s72, s76, s6
    s_cmp_ge_u32 s72, 22
    s_cselect_b32 s3, 22, 0
    s_sub_u32 s72, s72, s3
    s_lshl_b32 s72, s72, 14
    s_add_u32 s72, s72, s74
    s_lshl_b32 s71, s76, 11
    s_add_u32 s71, s71, s75
    s_add_u32 m0, s71, 0
    s_nop 0
    buffer_load_dwordx4 v16, s[28:31], s72 offen lds
    buffer_load_dwordx4 v17, s[28:31], s72 offen offset:1024 lds
    s_add_u32 m0, s71, 16384
    s_add_u32 s72, s72, 360448
    buffer_load_dwordx4 v16, s[28:31], s72 offen lds
    buffer_load_dwordx4 v17, s[28:31], s72 offen offset:1024 lds
    s_add_u32 s76, s76, 1
    s_cmp_eq_u32 s76, 8
    s_cselect_b32 s76, 0, s76
    s_add_u32 s72, s76, s6
    s_cmp_ge_u32 s72, 22
    s_cselect_b32 s3, 22, 0
    s_sub_u32 s72, s72, s3
    s_lshl_b32 s72, s72, 14
    s_add_u32 s72, s72, s74
    s_lshl_b32 s71, s76, 11
    s_add_u32 s71, s71, s75
    s_add_u32 m0, s71, 0
    s_nop 0
    buffer_load_dwordx4 v16, s[28:31], s72 offen lds
    buffer_load_dwordx4 v17, s[28:31], s72 offen offset:1024 lds
    s_add_u32 m0, s71, 16384
    s_add_u32 s72, s72, 360448
    buffer_load_dwordx4 v16, s[28:31], s72 offen lds
    buffer_load_dwordx4 v17, s[28:31], s72 offen offset:1024 lds
    s_add_u32 s76, s76, 1
    s_cmp_eq_u32 s76, 8
    s_cselect_b32 s76, 0, s76
    s_add_u32 s72, s76, s6
    s_cmp_ge_u32 s72, 22
    s_cselect_b32 s3, 22, 0
    s_sub_u32 s72, s72, s3
    s_lshl_b32 s72, s72, 14
    s_add_u32 s72, s72, s74
    s_lshl_b32 s71, s76, 11
    s_add_u32 s71, s71, s75
    s_add_u32 m0, s71, 0
    s_nop 0
    buffer_load_dwordx4 v16, s[28:31], s72 offen lds
    buffer_load_dwordx4 v17, s[28:31], s72 offen offset:1024 lds
    s_add_u32 m0, s71, 16384
    s_add_u32 s72, s72, 360448
    buffer_load_dwordx4 v16, s[28:31], s72 offen lds
    buffer_load_dwordx4 v17, s[28:31], s72 offen offset:1024 lds
    s_add_u32 s76, s76, 1
    s_cmp_eq_u32 s76, 8
    s_cselect_b32 s76, 0, s76
    s_add_u32 s72, s76, s6
    s_cmp_ge_u32 s72, 22
    s_cselect_b32 s3, 22, 0
    s_sub_u32 s72, s72, s3
    s_lshl_b32 s72, s72, 14
    s_add_u32 s72, s72, s74
    s_lshl_b32 s71, s76, 11
    s_add_u32 s71, s71, s75
    s_add_u32 m0, s71, 0
    s_nop 0
    buffer_load_dwordx4 v16, s[28:31], s72 offen lds
    buffer_load_dwordx4 v17, s[28:31], s72 offen offset:1024 lds
    s_add_u32 m0, s71, 16384
    s_add_u32 s72, s72, 360448
    buffer_load_dwordx4 v16, s[28:31], s72 offen lds
    buffer_load_dwordx4 v17, s[28:31], s72 offen offset:1024 lds
    s_add_u32 s76, s76, 1
    s_cmp_eq_u32 s76, 8
    s_cselect_b32 s76, 0, s76
    s_add_u32 s72, s76, s6
    s_cmp_ge_u32 s72, 22
    s_cselect_b32 s3, 22, 0
    s_sub_u32 s72, s72, s3
    s_lshl_b32 s72, s72, 14
    s_add_u32 s72, s72, s74
    s_lshl_b32 s71, s76, 11
    s_add_u32 s71, s71, s75
    s_add_u32 m0, s71, 0
    s_nop 0
    buffer_load_dwordx4 v16, s[28:31], s72 offen lds
    buffer_load_dwordx4 v17, s[28:31], s72 offen offset:1024 lds
    s_add_u32 m0, s71, 16384
    s_add_u32 s72, s72, 360448
    buffer_load_dwordx4 v16, s[28:31], s72 offen lds
    buffer_load_dwordx4 v17, s[28:31], s72 offen offset:1024 lds
    s_add_u32 s76, s76, 1
    s_cmp_eq_u32 s76, 8
    s_cselect_b32 s76, 0, s76
    s_add_u32 s72, s76, s6
    s_cmp_ge_u32 s72, 22
    s_cselect_b32 s3, 22, 0
    s_sub_u32 s72, s72, s3
    s_lshl_b32 s72, s72, 14
    s_add_u32 s72, s72, s74
    s_lshl_b32 s71, s76, 11
    s_add_u32 s71, s71, s75
    s_add_u32 m0, s71, 0
    s_nop 0
    buffer_load_dwordx4 v16, s[28:31], s72 offen lds
    buffer_load_dwordx4 v17, s[28:31], s72 offen offset:1024 lds
    s_add_u32 m0, s71, 16384
    s_add_u32 s72, s72, 360448
    buffer_load_dwordx4 v16, s[28:31], s72 offen lds
    buffer_load_dwordx4 v17, s[28:31], s72 offen offset:1024 lds
    s_add_u32 s76, s76, 1
    s_cmp_eq_u32 s76, 8
    s_cselect_b32 s76, 0, s76
    s_barrier
    s_mul_i32 s75, s66, 49152
    s_add_u32 s75, s75, 49152
    s_and_b32 s76, s62, 3
    s_mul_i32 s76, s76, 3
    s_add_u32 s76, s76, 8
    s_add_u32 s72, s76, s6
    s_cmp_ge_u32 s72, 22
    s_cselect_b32 s3, 22, 0
    s_sub_u32 s72, s72, s3
    s_lshl_b32 s72, s72, 14
    s_add_u32 s72, s72, s74
    s_lshl_b32 s71, s76, 11
    s_add_u32 s71, s71, s75
    s_add_u32 m0, s71, 0
    s_nop 0
    buffer_load_dwordx4 v16, s[28:31], s72 offen lds
    buffer_load_dwordx4 v17, s[28:31], s72 offen offset:1024 lds
    s_waitcnt vmcnt(8)
    s_add_u32 m0, s71, 24576
    s_add_u32 s72, s72, 360448
    buffer_load_dwordx4 v16, s[28:31], s72 offen lds
    buffer_load_dwordx4 v17, s[28:31], s72 offen offset:1024 lds
    s_waitcnt vmcnt(8)
    s_add_u32 s76, s76, 1
    s_cmp_eq_u32 s76, 20
    s_cselect_b32 s76, 8, s76
    s_add_u32 s72, s76, s6
    s_cmp_ge_u32 s72, 22
    s_cselect_b32 s3, 22, 0
    s_sub_u32 s72, s72, s3
    s_lshl_b32 s72, s72, 14
    s_add_u32 s72, s72, s74
    s_lshl_b32 s71, s76, 11
    s_add_u32 s71, s71, s75
    s_add_u32 m0, s71, 0
    s_nop 0
    buffer_load_dwordx4 v16, s[28:31], s72 offen lds
    buffer_load_dwordx4 v17, s[28:31], s72 offen offset:1024 lds
    s_waitcnt vmcnt(8)
    s_add_u32 m0, s71, 24576
    s_add_u32 s72, s72, 360448
    buffer_load_dwordx4 v16, s[28:31], s72 offen lds
    buffer_load_dwordx4 v17, s[28:31], s72 offen offset:1024 lds
    s_waitcnt vmcnt(8)
    s_add_u32 s76, s76, 1
    s_cmp_eq_u32 s76, 20
    s_cselect_b32 s76, 8, s76
    s_add_u32 s72, s76, s6
    s_cmp_ge_u32 s72, 22
    s_cselect_b32 s3, 22, 0
    s_sub_u32 s72, s72, s3
    s_lshl_b32 s72, s72, 14
    s_add_u32 s72, s72, s74
    s_lshl_b32 s71, s76, 11
    s_add_u32 s71, s71, s75
    s_add_u32 m0, s71, 0
    s_nop 0
    buffer_load_dwordx4 v16, s[28:31], s72 offen lds
    buffer_load_dwordx4 v17, s[28:31], s72 offen offset:1024 lds
    s_waitcnt vmcnt(8)
    s_add_u32 m0, s71, 24576
    s_add_u32 s72, s72, 360448
    buffer_load_dwordx4 v16, s[28:31], s72 offen lds
    buffer_load_dwordx4 v17, s[28:31], s72 offen offset:1024 lds
    s_waitcnt vmcnt(8)
    s_add_u32 s76, s76, 1
    s_cmp_eq_u32 s76, 20
    s_cselect_b32 s76, 8, s76
    s_add_u32 s72, s76, s6
    s_cmp_ge_u32 s72, 22
    s_cselect_b32 s3, 22, 0
    s_sub_u32 s72, s72, s3
    s_lshl_b32 s72, s72, 14
    s_add_u32 s72, s72, s74
    s_lshl_b32 s71, s76, 11
    s_add_u32 s71, s71, s75
    s_add_u32 m0, s71, 0
    s_nop 0
    buffer_load_dwordx4 v16, s[28:31], s72 offen lds
    buffer_load_dwordx4 v17, s[28:31], s72 offen offset:1024 lds
    s_waitcnt vmcnt(8)
    s_add_u32 m0, s71, 24576
    s_add_u32 s72, s72, 360448
    buffer_load_dwordx4 v16, s[28:31], s72 offen lds
    buffer_load_dwordx4 v17, s[28:31], s72 offen offset:1024 lds
    s_waitcnt vmcnt(8)
    s_add_u32 s76, s76, 1
    s_cmp_eq_u32 s76, 20
    s_cselect_b32 s76, 8, s76
    s_add_u32 s72, s76, s6
    s_cmp_ge_u32 s72, 22
    s_cselect_b32 s3, 22, 0
    s_sub_u32 s72, s72, s3
    s_lshl_b32 s72, s72, 14
    s_add_u32 s72, s72, s74
    s_lshl_b32 s71, s76, 11
    s_add_u32 s71, s71, s75
    s_add_u32 m0, s71, 0
    s_nop 0
    buffer_load_dwordx4 v16, s[28:31], s72 offen lds
    buffer_load_dwordx4 v17, s[28:31], s72 offen offset:1024 lds
    s_waitcnt vmcnt(8)
    s_add_u32 m0, s71, 24576
    s_add_u32 s72, s72, 360448
    buffer_load_dwordx4 v16, s[28:31], s72 offen lds
    buffer_load_dwordx4 v17, s[28:31], s72 offen offset:1024 lds
    s_waitcnt vmcnt(8)
    s_add_u32 s76, s76, 1
    s_cmp_eq_u32 s76, 20
    s_cselect_b32 s76, 8, s76
    s_add_u32 s72, s76, s6
    s_cmp_ge_u32 s72, 22
    s_cselect_b32 s3, 22, 0
    s_sub_u32 s72, s72, s3
    s_lshl_b32 s72, s72, 14
    s_add_u32 s72, s72, s74
    s_lshl_b32 s71, s76, 11
    s_add_u32 s71, s71, s75
    s_add_u32 m0, s71, 0
    s_nop 0
    buffer_load_dwordx4 v16, s[28:31], s72 offen lds
    buffer_load_dwordx4 v17, s[28:31], s72 offen offset:1024 lds
    s_waitcnt vmcnt(8)
    s_add_u32 m0, s71, 24576
    s_add_u32 s72, s72, 360448
    buffer_load_dwordx4 v16, s[28:31], s72 offen lds
    buffer_load_dwordx4 v17, s[28:31], s72 offen offset:1024 lds
    s_waitcnt vmcnt(8)
    s_add_u32 s76, s76, 1
    s_cmp_eq_u32 s76, 20
    s_cselect_b32 s76, 8, s76
    s_add_u32 s72, s76, s6
    s_cmp_ge_u32 s72, 22
    s_cselect_b32 s3, 22, 0
    s_sub_u32 s72, s72, s3
    s_lshl_b32 s72, s72, 14
    s_add_u32 s72, s72, s74
    s_lshl_b32 s71, s76, 11
    s_add_u32 s71, s71, s75
    s_add_u32 m0, s71, 0
    s_nop 0
    buffer_load_dwordx4 v16, s[28:31], s72 offen lds
    buffer_load_dwordx4 v17, s[28:31], s72 offen offset:1024 lds
    s_waitcnt vmcnt(8)
    s_add_u32 m0, s71, 24576
    s_add_u32 s72, s72, 360448
    buffer_load_dwordx4 v16, s[28:31], s72 offen lds
    buffer_load_dwordx4 v17, s[28:31], s72 offen offset:1024 lds
    s_waitcnt vmcnt(8)
    s_add_u32 s76, s76, 1
    s_cmp_eq_u32 s76, 20
    s_cselect_b32 s76, 8, s76
    s_add_u32 s72, s76, s6
    s_cmp_ge_u32 s72, 22
    s_cselect_b32 s3, 22, 0
    s_sub_u32 s72, s72, s3
    s_lshl_b32 s72, s72, 14
    s_add_u32 s72, s72, s74
    s_lshl_b32 s71, s76, 11
    s_add_u32 s71, s71, s75
    s_add_u32 m0, s71, 0
    s_nop 0
    buffer_load_dwordx4 v16, s[28:31], s72 offen lds
    buffer_load_dwordx4 v17, s[28:31], s72 offen offset:1024 lds
    s_waitcnt vmcnt(8)
    s_add_u32 m0, s71, 24576
    s_add_u32 s72, s72, 360448
    buffer_load_dwordx4 v16, s[28:31], s72 offen lds
    buffer_load_dwordx4 v17, s[28:31], s72 offen offset:1024 lds
    s_waitcnt vmcnt(8)
    s_add_u32 s76, s76, 1
    s_cmp_eq_u32 s76, 20
    s_cselect_b32 s76, 8, s76
    s_add_u32 s72, s76, s6
    s_cmp_ge_u32 s72, 22
    s_cselect_b32 s3, 22, 0
    s_sub_u32 s72, s72, s3
    s_lshl_b32 s72, s72, 14
    s_add_u32 s72, s72, s74
    s_lshl_b32 s71, s76, 11
    s_add_u32 s71, s71, s75
    s_add_u32 m0, s71, 0
    s_nop 0
    buffer_load_dwordx4 v16, s[28:31], s72 offen lds
    buffer_load_dwordx4 v17, s[28:31], s72 offen offset:1024 lds
    s_waitcnt vmcnt(8)
    s_add_u32 m0, s71, 24576
    s_add_u32 s72, s72, 360448
    buffer_load_dwordx4 v16, s[28:31], s72 offen lds
    buffer_load_dwordx4 v17, s[28:31], s72 offen offset:1024 lds
    s_waitcnt vmcnt(8)
    s_add_u32 s76, s76, 1
    s_cmp_eq_u32 s76, 20
    s_cselect_b32 s76, 8, s76
    s_add_u32 s72, s76, s6
    s_cmp_ge_u32 s72, 22
    s_cselect_b32 s3, 22, 0
    s_sub_u32 s72, s72, s3
    s_lshl_b32 s72, s72, 14
    s_add_u32 s72, s72, s74
    s_lshl_b32 s71, s76, 11
    s_add_u32 s71, s71, s75
    s_add_u32 m0, s71, 0
    s_nop 0
    buffer_load_dwordx4 v16, s[28:31], s72 offen lds
    buffer_load_dwordx4 v17, s[28:31], s72 offen offset:1024 lds
    s_waitcnt vmcnt(8)
    s_add_u32 m0, s71, 24576
    s_add_u32 s72, s72, 360448
    buffer_load_dwordx4 v16, s[28:31], s72 offen lds
    buffer_load_dwordx4 v17, s[28:31], s72 offen offset:1024 lds
    s_waitcnt vmcnt(8)
    s_add_u32 s76, s76, 1
    s_cmp_eq_u32 s76, 20
    s_cselect_b32 s76, 8, s76
    s_add_u32 s72, s76, s6
    s_cmp_ge_u32 s72, 22
    s_cselect_b32 s3, 22, 0
    s_sub_u32 s72, s72, s3
    s_lshl_b32 s72, s72, 14
    s_add_u32 s72, s72, s74
    s_lshl_b32 s71, s76, 11
    s_add_u32 s71, s71, s75
    s_add_u32 m0, s71, 0
    s_nop 0
    buffer_load_dwordx4 v16, s[28:31], s72 offen lds
    buffer_load_dwordx4 v17, s[28:31], s72 offen offset:1024 lds
    s_waitcnt vmcnt(8)
    s_add_u32 m0, s71, 24576
    s_add_u32 s72, s72, 360448
    buffer_load_dwordx4 v16, s[28:31], s72 offen lds
    buffer_load_dwordx4 v17, s[28:31], s72 offen offset:1024 lds
    s_waitcnt vmcnt(8)
    s_add_u32 s76, s76, 1
    s_cmp_eq_u32 s76, 20
    s_cselect_b32 s76, 8, s76
    s_add_u32 s72, s76, s6
    s_cmp_ge_u32 s72, 22
    s_cselect_b32 s3, 22, 0
    s_sub_u32 s72, s72, s3
    s_lshl_b32 s72, s72, 14
    s_add_u32 s72, s72, s74
    s_lshl_b32 s71, s76, 11
    s_add_u32 s71, s71, s75
    s_add_u32 m0, s71, 0
    s_nop 0
    buffer_load_dwordx4 v16, s[28:31], s72 offen lds
    buffer_load_dwordx4 v17, s[28:31], s72 offen offset:1024 lds
    s_waitcnt vmcnt(8)
    s_add_u32 m0, s71, 24576
    s_add_u32 s72, s72, 360448
    buffer_load_dwordx4 v16, s[28:31], s72 offen lds
    buffer_load_dwordx4 v17, s[28:31], s72 offen offset:1024 lds
    s_waitcnt vmcnt(8)
    s_add_u32 s76, s76, 1
    s_cmp_eq_u32 s76, 20
    s_cselect_b32 s76, 8, s76
    s_waitcnt vmcnt(0)
    s_barrier
    s_branch L_HEND
L_TOUCH:
    s_getpc_b64 s[74:75]
L_PC:
    s_sub_u32 s74, s74, L_PC-sequential_preLN__linear_kernel_hedgehog__dense_activation_gelu__prompt_kernel
    s_subb_u32 s75, s75, 0
    v_lshlrev_b32 v1, 5, v0
    v_add_u32 v1, s61, v1
    v_lshlrev_b32 v1, 7, v1
    s_mov_b32 s70, L_END-sequential_preLN__linear_kernel_hedgehog__dense_activation_gelu__prompt_kernel
    v_cmp_gt_u32 vcc, s70, v1
    s_nop 0
    s_and_saveexec_b64 s[72:73], vcc
    global_load_dword v251, v1, s[74:75]
    s_mov_b64 exec, -1
    v_lshlrev_b32 v5, 7, v0
    s_waitcnt lgkmcnt(0)
    s_mov_b32 s16, s58
    s_mov_b32 s17, s59
    s_mov_b32 s18, 33554432
    s_mov_b32 s19, 0x20000
    s_barrier
    s_barrier
    s_barrier
    s_barrier
    s_barrier
    s_barrier
    s_mov_b32 s28, s38
    s_mov_b32 s29, s39
    s_mov_b32 s30, 1572864
    s_mov_b32 s31, 0x20000
    v_lshrrev_b32 v1, 3, v0
    v_mul_u32_u24 v1, 3072, v1
    v_and_b32 v2, 7, v0
    v_lshl_add_u32 v6, v2, 7, v1
    s_mul_i32 s70, s61, 49152
    s_add_u32 s73, s70, 0
    buffer_load_dword v250, v6, s[28:31], s73 offen
    s_add_u32 s73, s70, 24576
    buffer_load_dword v250, v6, s[28:31], s73 offen
    s_lshl_b32 s70, s62, 3
    s_add_u32 s70, s70, s63
    s_mul_i32 s70, s70, 12288
    s_add_u32 s70, s70, 6291456
    s_lshr_b32 s71, s22, 1
    s_mul_i32 s71, s71, 6144
    s_add_u32 s72, s70, s71
    s_sub_u32 s70, s70, s71
    s_add_u32 s70, s70, 6144
    s_mov_b64 exec, -1
    s_mov_b32 exec_hi, 0xffff
    s_add_u32 s73, s70, 0
    buffer_load_dword v250, v5, s[16:19], s73 offen
    s_mov_b64 exec, -1
    s_mov_b64 exec, 0xffffffff
    s_add_u32 s73, s72, 0
    buffer_load_dword v250, v5, s[16:19], s73 offen
    s_mov_b64 exec, -1
    s_lshl_b32 s70, s64, 8
    s_add_u32 s70, s70, 4718592
    v_and_b32 v1, 1, v0
    v_lshlrev_b32 v1, 7, v1
    v_lshrrev_b32 v2, 1, v0
    v_lshl_add_u32 v6, v2, 12, v1
    s_mov_b64 exec, 0x3ff
    s_add_u32 s73, s70, 0
    buffer_load_dword v250, v6, s[16:19], s73 offen
    s_mov_b64 exec, -1
    s_lshl_b32 s70, s2, 4
    s_add_u32 s70, s70, 4722688
    s_mov_b64 exec, 0x1
    s_add_u32 s73, s70, 0
    buffer_load_dword v250, v5, s[16:19], s73 offen
    s_mov_b64 exec, -1
    s_lshl_b32 s70, s21, 2
    s_and_b32 s72, s22, 3
    s_add_u32 s70, s70, s72
    s_mul_i32 s70, s70, 24576
    s_lshl_b32 s72, s23, 7
    s_add_u32 s70, s70, s72
    s_add_u32 s70, s70, 14682112
    v_mul_u32_u24 v6, 3072, v0
    s_mov_b64 exec, 0xff
    s_add_u32 s73, s70, 0
    buffer_load_dword v250, v6, s[16:19], s73 offen
    s_mov_b64 exec, -1
    s_mov_b32 s24, s42
    s_mov_b32 s25, s43
    s_mov_b32 s26, 524288
    s_mov_b32 s27, 0x20000
    s_lshl_b32 s70, s61, 14
    s_add_u32 s73, s70, 0
    buffer_load_dword v250, v5, s[24:27], s73 offen
    s_add_u32 s73, s70, 8192
    buffer_load_dword v250, v5, s[24:27], s73 offen
    s_mov_b32 s28, s46
    s_mov_b32 s29, s47
    s_mov_b32 s30, 1409024
    s_mov_b32 s31, 0x20000
    s_mul_i32 s70, s61, 22016
    s_add_u32 s73, s70, 0
    buffer_load_dword v250, v5, s[28:31], s73 offen
    s_add_u32 s73, s70, 8192
    buffer_load_dword v250, v5, s[28:31], s73 offen
    s_mov_b64 exec, -1
    s_mov_b32 exec_hi, 0xfff
    s_add_u32 s73, s70, 16384
    buffer_load_dword v250, v5, s[28:31], s73 offen
    s_mov_b64 exec, -1
    s_barrier
    s_barrier
    s_branch L_HEND
L_REG:
    v_mov_b32 v10, 1
    v_mov_b32 v11, 156992
    v_mov_b32 v12, 162880
    v_cmp_eq_u32 vcc, 0, v0
    s_nop 1
    v_cndmask_b32 v11, v12, v11, vcc
    v_mov_b32 v12, 0
    v_mov_b32 v13, 0
    v_mov_b32 v14, 0
    v_mov_b32 v15, 0
    s_mov_b64 exec, 3
    ds_write_b128 v11, v[12:15] offset:0
    ds_write_b128 v11, v[12:15] offset:16
    ds_write_b128 v11, v[12:15] offset:32
    ds_write_b128 v11, v[12:15] offset:48
    s_mov_b64 exec, -1
    v_mov_b32 v6, 156992
    s_waitcnt lgkmcnt(0)
    s_mov_b32 s44, s3
    s_add_u32 s70, s58, 4747264
    s_addc_u32 s71, s59, 0
    s_load_dword s69, s[70:71], 0
    s_mov_b32 s16, s58
    s_mov_b32 s17, s59
    s_mov_b32 s18, 33554432
    s_mov_b32 s19, 0x20000
    v_mov_b32 v21, 0
    s_getreg_b32 s76, hwreg(HW_REG_XCC_ID)
    s_and_b32 s76, s76, 7
    s_mov_b32 s77, s22
    s_waitcnt lgkmcnt(0)
    s_add_u32 s69, s69, 16
    s_and_b32 s69, s69, -16
    s_or_b32 s69, s69, 8
    s_or_b32 s75, s69, s76
    v_mov_b32 v22, s75
    s_lshl_b32 s74, s60, 7
    s_add_u32 s74, s74, 4743168
    s_lshl_b32 s70, s61, 2
    s_add_u32 s70, s70, s74
    s_mov_b64 exec, 1
    buffer_store_dword v22, v21, s[16:19], s70 offen sc1
    s_mov_b64 exec, -1
    s_lshl_b32 s7, s21, 2
    s_and_b32 s70, s77, 3
    s_add_u32 s7, s7, s70
    s_mul_i32 s7, s7, 2304
    s_add_u32 s7, s7, 13631488
    s_cmp_lg_u32 s23, 0
    s_cbranch_scc1 S_NOZ
    s_cmp_ge_u32 s77, 4
    s_cbranch_scc1 S_NOZ
    buffer_store_dwordx4 v[12:15], v4, s[16:19], s7 offen sc1
    buffer_store_dwordx4 v[12:15], v4, s[16:19], s7 offen offset:1024 sc1
    s_mov_b64 exec, 0xff
    buffer_store_dwordx4 v[12:15], v4, s[16:19], s7 offen offset:2048 sc1
    s_mov_b64 exec, -1
S_NOZ:
    v_lshlrev_b32 v20, 2, v0
    v_and_b32 v20, 127, v20
    s_barrier
    s_barrier
    s_barrier
    s_cmp_lg_u32 s23, 0
    s_cbranch_scc1 S_NOZ2
    s_cmp_ge_u32 s77, 4
    s_cbranch_scc1 S_NOZ2
    s_mov_b64 exec, 0xff
    v_mov_b32 v12, s69
    s_waitcnt vmcnt(0)
    buffer_store_dwordx4 v[12:15], v4, s[16:19], s7 offen offset:2176 sc1
    s_mov_b64 exec, -1
S_NOZ2:
    buffer_load_dword v24, v20, s[16:19], s74 offen sc1
    s_barrier
    s_barrier
    s_barrier
    s_barrier
    s_barrier
S_RP:
    s_waitcnt vmcnt(0)
    v_and_b32 v25, -8, v24
    v_cmp_ne_u32 vcc, s69, v25
    s_cbranch_vccz S_ROK
    buffer_load_dword v24, v20, s[16:19], s74 offen sc1
    s_sub_u32 s5, s5, 1
    s_cmp_lt_i32 s5, 0
    s_cbranch_scc0 S_RP
S_ROK:
    s_waitcnt vmcnt(0)
    v_cmp_ne_u32 vcc, s75, v24
    s_nop 0
    s_cmp_eq_u64 vcc, 0
    s_cselect_b32 s4, 1, 0
    v_mov_b32 v23, s4
    s_mov_b64 exec, 3
    ds_write_b32 v11, v23 offset:20
    s_mov_b64 exec, -1
    s_cmp_lt_u32 s77, 4
    s_cbranch_scc1 S_SERVE
    s_mov_b64 exec, 3
    ds_add_u32 v11, v10 offset:0
    s_mov_b64 exec, -1
    s_mov_b64 exec, 3
    ds_add_u32 v11, v10 offset:8
    s_mov_b64 exec, -1
    s_branch L_HEND
S_SERVE:
    s_lshr_b32 s70, s77, 1
    s_lshl_b32 s70, s70, 14
    s_and_b32 s71, s77, 1
    s_mul_i32 s72, s71, 4352
    s_add_u32 s72, s72, s70
    s_add_u32 s72, s72, 131072
    v_lshl_add_u32 v9, v0, 2, s72
    s_mul_i32 s72, s71, 3840
    s_add_u32 s72, s72, s70
    s_add_u32 s72, s72, 131328
    v_bfe_u32 v7, v0, 2, 3
    v_lshlrev_b32 v7, 9, v7
    v_and_b32 v3, 3, v0
    v_lshl_add_u32 v7, v3, 2, v7
    v_add_u32 v7, s72, v7
    s_lshl_b32 s74, s60, 5
    s_add_u32 s74, s74, s63
    s_lshl_b32 s74, s74, 2
    s_add_u32 s74, s74, s77
    s_mul_i32 s74, s74, 3072
    s_add_u32 s74, s74, 6291456
    s_xor_b32 s70, s77, 1
    s_mul_i32 s70, s70, 98304
    s_add_u32 s9, s74, s70
    s_and_b32 s70, s77, 1
    s_mul_i32 s70, s70, 3072
    s_sub_u32 s9, s9, s70
    s_xor_b32 s70, s77, 2
    s_mul_i32 s70, s70, 98304
    s_add_u32 s10, s74, s70
    s_xor_b32 s70, s77, 3
    s_mul_i32 s70, s70, 98304
    s_add_u32 s11, s74, s70
    s_lshl_b32 s70, s21, 2
    s_add_u32 s70, s70, s77
    s_lshl_b32 s70, s70, 3
    s_add_u32 s70, s70, s23
    s_mul_i32 s70, s70, 3072
    s_add_u32 s8, s70, 14680064
S_ZP:
    buffer_load_dword v24, v21, s[16:19], s7 offen offset:2176 sc1
    s_sub_u32 s5, s5, 1
    s_cmp_lt_i32 s5, 0
    s_cbranch_scc1 S_ZOK
    s_waitcnt vmcnt(0)
    v_readfirstlane_b32 s70, v24
    s_nop 0
    s_sub_u32 s70, s70, s69
    s_cmp_ge_u32 s70, 8
    s_cbranch_scc1 S_ZP
S_ZOK:
    v_lshlrev_b32 v6, 2, v0
    s_setprio 3
CW9:
    ds_read_b32 v26, v11 offset:12
    s_sub_u32 s5, s5, 1
    s_cmp_lt_i32 s5, 0
    s_cbranch_scc1 CE10
    s_waitcnt lgkmcnt(0)
    v_readfirstlane_b32 s3, v26
    s_nop 0
    s_cmp_lt_u32 s3, 4
    s_cbranch_scc0 CE10
    s_sleep 1
    s_branch CW9
CE10:
    ds_read2st64_b32 v[64:65], v9 offset0:0 offset1:32
    ds_read2st64_b32 v[66:67], v9 offset0:2 offset1:34
    ds_read2st64_b32 v[68:69], v9 offset0:4 offset1:36
    ds_read2st64_b32 v[70:71], v9 offset0:6 offset1:38
    ds_read2st64_b32 v[72:73], v9 offset0:8 offset1:40
    ds_read2st64_b32 v[74:75], v9 offset0:10 offset1:42
    ds_read2st64_b32 v[76:77], v9 offset0:12 offset1:44
    ds_read2st64_b32 v[78:79], v9 offset0:14 offset1:46
    ds_read2st64_b32 v[80:81], v7 offset0:0 offset1:32
    s_waitcnt lgkmcnt(8)
    v_add_f32 v32, v64, v65
    s_waitcnt lgkmcnt(7)
    v_add_f32 v33, v66, v67
    s_waitcnt lgkmcnt(6)
    v_add_f32 v34, v68, v69
    s_waitcnt lgkmcnt(5)
    v_add_f32 v36, v70, v71
    s_waitcnt lgkmcnt(4)
    v_add_f32 v37, v72, v73
    s_waitcnt lgkmcnt(3)
    v_add_f32 v38, v74, v75
    s_waitcnt lgkmcnt(2)
    v_add_f32 v40, v76, v77
    s_waitcnt lgkmcnt(1)
    v_add_f32 v41, v78, v79
    s_waitcnt lgkmcnt(0)
    v_add_f32 v42, v80, v81
    s_mov_b64 exec, 3
    ds_add_u32 v11, v10 offset:0
    s_mov_b64 exec, -1
TP11:
    buffer_load_dwordx4 v[64:67], v4, s[16:19], s9 offen offset:0 sc1
    buffer_load_dwordx4 v[68:71], v4, s[16:19], s9 offen offset:1024 sc1
    buffer_load_dwordx4 v[72:75], v4, s[16:19], s9 offen offset:2048 sc1
    buffer_load_dwordx4 v[76:79], v4, s[16:19], s10 offen offset:0 sc1
    buffer_load_dwordx4 v[80:83], v4, s[16:19], s10 offen offset:1024 sc1
    buffer_load_dwordx4 v[84:87], v4, s[16:19], s10 offen offset:2048 sc1
    buffer_load_dwordx4 v[88:91], v4, s[16:19], s11 offen offset:0 sc1
    buffer_load_dwordx4 v[92:95], v4, s[16:19], s11 offen offset:1024 sc1
    buffer_load_dwordx4 v[96:99], v4, s[16:19], s11 offen offset:2048 sc1
    s_sub_u32 s5, s5, 1
    s_cmp_lt_i32 s5, 0
    s_cbranch_scc1 TE12
    s_waitcnt vmcnt(0)
    v_xor_b32 v62, s69, v67
    v_xor_b32 v63, s69, v71
    v_or_b32 v62, v62, v63
    v_xor_b32 v63, s69, v75
    v_or_b32 v62, v62, v63
    v_xor_b32 v63, s69, v79
    v_or_b32 v62, v62, v63
    v_xor_b32 v63, s69, v83
    v_or_b32 v62, v62, v63
    v_xor_b32 v63, s69, v87
    v_or_b32 v62, v62, v63
    v_xor_b32 v63, s69, v91
    v_or_b32 v62, v62, v63
    v_xor_b32 v63, s69, v95
    v_or_b32 v62, v62, v63
    v_xor_b32 v63, s69, v99
    v_or_b32 v62, v62, v63
    v_cmp_ne_u32 vcc, 0, v62
    s_cbranch_vccnz TP11
TE12:
    s_waitcnt vmcnt(0)
    v_pk_add_f32 v[32:33], v[32:33], v[64:65]
    v_pk_add_f32 v[34:35], v[34:35], v[66:67]
    v_pk_add_f32 v[36:37], v[36:37], v[68:69]
    v_pk_add_f32 v[38:39], v[38:39], v[70:71]
    v_pk_add_f32 v[40:41], v[40:41], v[72:73]
    v_pk_add_f32 v[42:43], v[42:43], v[74:75]
    v_pk_add_f32 v[32:33], v[32:33], v[76:77]
    v_pk_add_f32 v[34:35], v[34:35], v[78:79]
    v_pk_add_f32 v[36:37], v[36:37], v[80:81]
    v_pk_add_f32 v[38:39], v[38:39], v[82:83]
    v_pk_add_f32 v[40:41], v[40:41], v[84:85]
    v_pk_add_f32 v[42:43], v[42:43], v[86:87]
    v_pk_add_f32 v[32:33], v[32:33], v[88:89]
    v_pk_add_f32 v[34:35], v[34:35], v[90:91]
    v_pk_add_f32 v[36:37], v[36:37], v[92:93]
    v_pk_add_f32 v[38:39], v[38:39], v[94:95]
    v_pk_add_f32 v[40:41], v[40:41], v[96:97]
    v_pk_add_f32 v[42:43], v[42:43], v[98:99]
    buffer_atomic_add_f32 v32, v6, s[16:19], s7 offen offset:0
    buffer_atomic_add_f32 v33, v6, s[16:19], s7 offen offset:256
    buffer_atomic_add_f32 v34, v6, s[16:19], s7 offen offset:512
    buffer_atomic_add_f32 v36, v6, s[16:19], s7 offen offset:768
    buffer_atomic_add_f32 v37, v6, s[16:19], s7 offen offset:1024
    buffer_atomic_add_f32 v38, v6, s[16:19], s7 offen offset:1280
    buffer_atomic_add_f32 v40, v6, s[16:19], s7 offen offset:1536
    buffer_atomic_add_f32 v41, v6, s[16:19], s7 offen offset:1792
    s_mov_b64 exec, 0xffffffff
    buffer_atomic_add_f32 v42, v6, s[16:19], s7 offen offset:2048
    s_mov_b64 exec, -1
    v_mov_b32 v15, s69
    s_waitcnt vmcnt(0)
    buffer_store_dwordx4 v[12:15], v4, s[16:19], s8 offen offset:2048 sc1
    s_mov_b64 exec, -1
    s_mov_b32 s28, s46
    s_mov_b32 s29, s47
    s_mov_b32 s30, 1409024
    s_mov_b32 s31, 0x20000
    v_lshlrev_b32 v6, 7, v0
    s_mul_i32 s70, s61, 22016
    s_add_u32 s70, s70, 704512
    buffer_load_dword v250, v6, s[28:31], s70 offen
    s_add_u32 s70, s70, 8192
    buffer_load_dword v250, v6, s[28:31], s70 offen
    s_add_u32 s70, s70, 8192
    s_mov_b64 exec, -1
    s_mov_b32 exec_hi, 0xfff
    buffer_load_dword v250, v6, s[28:31], s70 offen
    s_add_u32 s70, s70, 8192
    s_mov_b64 exec, -1
L_HEND:
    s_endpgm
L_COMPUTE:
    s_and_b32 s67, s66, 1
    s_lshr_b32 s68, s66, 1
    v_and_b32 v1, 31, v0
    v_lshrrev_b32 v2, 5, v0
    v_lshrrev_b32 v3, 1, v1
    v_and_b32 v3, 7, v3
    v_xor_b32 v3, v3, v2
    v_lshlrev_b32 v3, 4, v3
    v_lshl_add_u32 v3, v1, 7, v3
    s_lshl_b32 s70, s67, 12
    v_add_u32 v3, s70, v3
    s_xor_b32 s70, s66, 0
    s_lshl_b32 s70, s70, 5
    v_xor_b32 v8, s70, v3
    s_xor_b32 s70, s66, 1
    s_lshl_b32 s70, s70, 5
    v_xor_b32 v9, s70, v3
    s_xor_b32 s70, s66, 2
    s_lshl_b32 s70, s70, 5
    v_xor_b32 v10, s70, v3
    s_xor_b32 s70, s66, 3
    s_lshl_b32 s70, s70, 5
    v_xor_b32 v11, s70, v3
    v_bfe_u32 v3, v0, 2, 2
    v_lshlrev_b32 v7, 7, v3
    v_lshrrev_b32 v3, 1, v3
    v_xor_b32 v3, s68, v3
    v_lshl_add_u32 v7, v3, 6, v7
    v_bfe_u32 v3, v0, 4, 1
    v_lshl_add_u32 v7, v3, 5, v7
    v_and_b32 v3, 3, v0
    v_lshl_add_u32 v7, v3, 3, v7
    v_add_u32 v7, 65536, v7
    v_lshl_add_u32 v60, v2, 11, v7
    v_lshl_add_u32 v61, v2, 10, v7
    s_xor_b32 s70, s66, 0
    s_lshl_b32 s71, s70, 12
    v_add_u32 v12, s71, v60
    s_lshl_b32 s71, s70, 11
    v_add_u32 v16, s71, v61
    s_xor_b32 s70, s66, 1
    s_lshl_b32 s71, s70, 12
    v_add_u32 v13, s71, v60
    s_lshl_b32 s71, s70, 11
    v_add_u32 v17, s71, v61
    s_xor_b32 s70, s66, 2
    s_lshl_b32 s71, s70, 12
    v_add_u32 v14, s71, v60
    s_lshl_b32 s71, s70, 11
    v_add_u32 v18, s71, v61
    s_xor_b32 s70, s66, 3
    s_lshl_b32 s71, s70, 12
    v_add_u32 v15, s71, v60
    s_lshl_b32 s71, s70, 11
    v_add_u32 v19, s71, v61
    v_mov_b32 v5, 0x3f803f80
    v_mov_b32 v6, 0
    v_lshrrev_b32 v3, 2, v0
    v_xor_b32 v3, v3, v0
    v_and_b32 v3, 4, v3
    v_and_b32 v7, 3, v0
    v_or_b32 v3, v3, v7
    v_cmp_eq_u32 vcc, 0, v3
    s_nop 1
    v_cndmask_b32 v20, 0, v5, vcc
    v_cndmask_b32 v21, 0, v5, vcc
    v_cndmask_b32 v22, 0, v5, vcc
    v_cndmask_b32 v23, 0, v5, vcc
    s_mov_b32 s32, 0x3b000000
    s_mov_b32 s33, 0x3727c5ac
    s_mov_b32 s34, 0x3fb8aa3b
    v_and_b32 v60, 1, v0
    v_cmp_eq_u32 vcc, 1, v60
    v_mov_b32 v61, 0x3f80
    v_mov_b32 v62, 0x3f800000
    v_cndmask_b32 v61, v61, v62, vcc
    v_bfe_u32 v60, v0, 2, 1
    v_cmp_eq_u32 vcc, v60, v2
    s_nop 1
    v_cndmask_b32 v61, 0, v61, vcc
    v_bfe_u32 v60, v0, 3, 2
    v_lshlrev_b32 v60, 1, v60
    v_bfe_u32 v62, v0, 1, 1
    v_or_b32 v60, v60, v62
    v_cmp_eq_u32 vcc, 0, v60
    s_nop 1
    v_cndmask_b32 v112, 0, v61, vcc
    v_cmp_eq_u32 vcc, 1, v60
    s_nop 1
    v_cndmask_b32 v113, 0, v61, vcc
    v_cmp_eq_u32 vcc, 2, v60
    s_nop 1
    v_cndmask_b32 v114, 0, v61, vcc
    v_cmp_eq_u32 vcc, 3, v60
    s_nop 1
    v_cndmask_b32 v115, 0, v61, vcc
    v_cmp_eq_u32 vcc, 4, v60
    s_nop 1
    v_cndmask_b32 v116, 0, v61, vcc
    v_cmp_eq_u32 vcc, 5, v60
    s_nop 1
    v_cndmask_b32 v117, 0, v61, vcc
    v_cmp_eq_u32 vcc, 6, v60
    s_nop 1
    v_cndmask_b32 v118, 0, v61, vcc
    v_cmp_eq_u32 vcc, 7, v60
    s_nop 1
    v_cndmask_b32 v119, 0, v61, vcc
    v_bfe_u32 v60, v0, 2, 2
    v_lshl_add_u32 v60, v2, 2, v60
    v_lshlrev_b32 v60, 5, v60
    v_and_b32 v61, 3, v0
    v_lshl_add_u32 v60, v61, 3, v60
    s_lshl_b32 s70, s66, 13
    s_add_u32 s70, s70, 131072
    v_add_u32 v60, s70, v60
    v_bfe_u32 v61, v0, 4, 1
    v_mul_u32_u24 v61, 0x8000, v61
    v_lshl_or_b32 v61, v61, 16, v61
    v_mov_b32 v111, 1
    v_mov_b32 v110, 156992
    v_mov_b32 v62, 162880
    v_cmp_eq_u32 vcc, 0, v0
    s_nop 1
    v_cndmask_b32 v110, v62, v110, vcc
    s_waitcnt lgkmcnt(0)
    s_mov_b32 s44, s3
    s_add_u32 s70, s58, 4747264
    s_addc_u32 s71, s59, 0
    s_load_dword s69, s[70:71], 0
    s_mov_b32 s8, s36
    s_mov_b32 s9, s37
    s_mov_b32 s10, 2097152
    s_mov_b32 s11, 0x20000
    s_mov_b32 s16, s58
    s_mov_b32 s17, s59
    s_mov_b32 s18, 33554432
    s_mov_b32 s19, 0x20000
    s_waitcnt lgkmcnt(0)
    s_add_u32 s69, s69, 16
    s_and_b32 s69, s69, -16
    s_or_b32 s69, s69, 8
    s_barrier
    ds_read_b128 v[36:39], v8 offset:0
    ds_read_b64_tr_b16 v[44:45], v12 offset:0
    ds_read_b64_tr_b16 v[46:47], v12 offset:512
    ds_read_b64_tr_b16 v[48:49], v12 offset:1024
    ds_read_b64_tr_b16 v[50:51], v12 offset:1536
    s_waitcnt lgkmcnt(2)
    v_mfma_f32_32x32x16_bf16 v[64:79], v[44:47], v[36:39], 0
    ds_read_b128 v[40:43], v9 offset:0
    ds_read_b64_tr_b16 v[52:53], v13 offset:0
    ds_read_b64_tr_b16 v[54:55], v13 offset:512
    v_mfma_f32_16x16x32_bf16 v[28:31], v[20:23], v[44:47], 0
    s_waitcnt lgkmcnt(3)
    v_mfma_f32_32x32x16_bf16 v[80:95], v[36:39], v[48:51], 0
    ds_read_b64_tr_b16 v[56:57], v13 offset:1024
    ds_read_b64_tr_b16 v[58:59], v13 offset:1536
    v_mfma_f32_16x16x32_bf16 v[32:35], v[20:23], v[48:51], 0
    s_waitcnt lgkmcnt(2)
    v_mfma_f32_32x32x16_bf16 v[64:79], v[52:55], v[40:43], v[64:79]
    ds_read_b128 v[36:39], v10 offset:0
    ds_read_b64_tr_b16 v[44:45], v14 offset:0
    ds_read_b64_tr_b16 v[46:47], v14 offset:512
    v_mfma_f32_16x16x32_bf16 v[24:27], v[20:23], v[40:43], 0
    s_waitcnt lgkmcnt(3)
    v_mfma_f32_32x32x16_bf16 v[80:95], v[40:43], v[56:59], v[80:95]
    ds_read_b64_tr_b16 v[48:49], v14 offset:1024
    ds_read_b64_tr_b16 v[50:51], v14 offset:1536
    v_dot2c_f32_bf16 v6, v40, v40
    v_dot2c_f32_bf16 v6, v41, v41
    v_dot2c_f32_bf16 v6, v42, v42
    v_dot2c_f32_bf16 v6, v43, v43
    s_waitcnt lgkmcnt(2)
    v_mfma_f32_32x32x16_bf16 v[64:79], v[44:47], v[36:39], v[64:79]
    ds_read_b128 v[40:43], v11 offset:0
    ds_read_b64_tr_b16 v[52:53], v15 offset:0
    ds_read_b64_tr_b16 v[54:55], v15 offset:512
    v_mfma_f32_16x16x32_bf16 v[24:27], v[20:23], v[36:39], v[24:27]
    s_waitcnt lgkmcnt(3)
    v_mfma_f32_32x32x16_bf16 v[80:95], v[36:39], v[48:51], v[80:95]
    ds_read_b64_tr_b16 v[56:57], v15 offset:1024
    ds_read_b64_tr_b16 v[58:59], v15 offset:1536
    v_dot2c_f32_bf16 v6, v36, v36
    v_dot2c_f32_bf16 v6, v37, v37
    v_dot2c_f32_bf16 v6, v38, v38
    v_dot2c_f32_bf16 v6, v39, v39
    s_barrier
    s_waitcnt lgkmcnt(2)
    v_mfma_f32_32x32x16_bf16 v[64:79], v[52:55], v[40:43], v[64:79]
    ds_read_b128 v[36:39], v8 offset:8192
    ds_read_b64_tr_b16 v[44:45], v12 offset:16384
    ds_read_b64_tr_b16 v[46:47], v12 offset:16896
    v_mfma_f32_16x16x32_bf16 v[28:31], v[20:23], v[52:55], v[28:31]
    s_waitcnt lgkmcnt(3)
    v_mfma_f32_32x32x16_bf16 v[80:95], v[40:43], v[56:59], v[80:95]
    ds_read_b64_tr_b16 v[48:49], v12 offset:17408
    ds_read_b64_tr_b16 v[50:51], v12 offset:17920
    v_mfma_f32_16x16x32_bf16 v[32:35], v[20:23], v[56:59], v[32:35]
    s_waitcnt lgkmcnt(2)
    v_mfma_f32_32x32x16_bf16 v[64:79], v[44:47], v[36:39], v[64:79]
    ds_read_b128 v[40:43], v9 offset:8192
    ds_read_b64_tr_b16 v[52:53], v13 offset:16384
    ds_read_b64_tr_b16 v[54:55], v13 offset:16896
    v_mfma_f32_16x16x32_bf16 v[28:31], v[20:23], v[44:47], v[28:31]
    s_waitcnt lgkmcnt(3)
    v_mfma_f32_32x32x16_bf16 v[80:95], v[36:39], v[48:51], v[80:95]
    ds_read_b64_tr_b16 v[56:57], v13 offset:17408
    ds_read_b64_tr_b16 v[58:59], v13 offset:17920
    v_mfma_f32_16x16x32_bf16 v[32:35], v[20:23], v[48:51], v[32:35]
    s_waitcnt lgkmcnt(2)
    v_mfma_f32_32x32x16_bf16 v[64:79], v[52:55], v[40:43], v[64:79]
    ds_read_b128 v[36:39], v10 offset:8192
    ds_read_b64_tr_b16 v[44:45], v14 offset:16384
    ds_read_b64_tr_b16 v[46:47], v14 offset:16896
    v_mfma_f32_16x16x32_bf16 v[24:27], v[20:23], v[40:43], v[24:27]
    s_waitcnt lgkmcnt(3)
    v_mfma_f32_32x32x16_bf16 v[80:95], v[40:43], v[56:59], v[80:95]
    ds_read_b64_tr_b16 v[48:49], v14 offset:17408
    ds_read_b64_tr_b16 v[50:51], v14 offset:17920
    v_dot2c_f32_bf16 v6, v40, v40
    v_dot2c_f32_bf16 v6, v41, v41
    v_dot2c_f32_bf16 v6, v42, v42
    v_dot2c_f32_bf16 v6, v43, v43
    s_waitcnt lgkmcnt(2)
    v_mfma_f32_32x32x16_bf16 v[64:79], v[44:47], v[36:39], v[64:79]
    ds_read_b128 v[40:43], v11 offset:8192
    ds_read_b64_tr_b16 v[52:53], v15 offset:16384
    ds_read_b64_tr_b16 v[54:55], v15 offset:16896
    v_mfma_f32_16x16x32_bf16 v[24:27], v[20:23], v[36:39], v[24:27]
    s_waitcnt lgkmcnt(3)
    v_mfma_f32_32x32x16_bf16 v[80:95], v[36:39], v[48:51], v[80:95]
    ds_read_b64_tr_b16 v[56:57], v15 offset:17408
    ds_read_b64_tr_b16 v[58:59], v15 offset:17920
    v_dot2c_f32_bf16 v6, v36, v36
    v_dot2c_f32_bf16 v6, v37, v37
    v_dot2c_f32_bf16 v6, v38, v38
    v_dot2c_f32_bf16 v6, v39, v39
    s_barrier
    s_waitcnt lgkmcnt(2)
    v_mfma_f32_32x32x16_bf16 v[64:79], v[52:55], v[40:43], v[64:79]
    ds_read_b128 v[36:39], v8 offset:16384
    ds_read_b64_tr_b16 v[44:45], v12 offset:32768
    ds_read_b64_tr_b16 v[46:47], v12 offset:33280
    v_mfma_f32_16x16x32_bf16 v[28:31], v[20:23], v[52:55], v[28:31]
    s_waitcnt lgkmcnt(3)
    v_mfma_f32_32x32x16_bf16 v[80:95], v[40:43], v[56:59], v[80:95]
    ds_read_b64_tr_b16 v[48:49], v12 offset:33792
    ds_read_b64_tr_b16 v[50:51], v12 offset:34304
    v_mfma_f32_16x16x32_bf16 v[32:35], v[20:23], v[56:59], v[32:35]
    ds_read_b64_tr_b16 v[120:121], v60 offset:0
    ds_read_b64_tr_b16 v[122:123], v60 offset:256
    ds_read_b64_tr_b16 v[124:125], v60 offset:512
    ds_read_b64_tr_b16 v[126:127], v60 offset:768
    s_waitcnt lgkmcnt(6)
    v_mfma_f32_32x32x16_bf16 v[64:79], v[44:47], v[36:39], v[64:79]
    ds_read_b128 v[40:43], v9 offset:16384
    ds_read_b64_tr_b16 v[52:53], v13 offset:32768
    ds_read_b64_tr_b16 v[54:55], v13 offset:33280
    v_mfma_f32_16x16x32_bf16 v[28:31], v[20:23], v[44:47], v[28:31]
    s_waitcnt lgkmcnt(3)
    v_mfma_f32_32x32x16_bf16 v[80:95], v[36:39], v[48:51], v[80:95]
    ds_read_b64_tr_b16 v[56:57], v13 offset:33792
    ds_read_b64_tr_b16 v[58:59], v13 offset:34304
    v_mfma_f32_16x16x32_bf16 v[32:35], v[20:23], v[48:51], v[32:35]
    v_xor_b32 v120, v120, v61
    v_xor_b32 v121, v121, v61
    v_xor_b32 v122, v122, v61
    v_xor_b32 v123, v123, v61
    v_xor_b32 v124, v124, v61
    v_xor_b32 v125, v125, v61
    v_xor_b32 v126, v126, v61
    v_xor_b32 v127, v127, v61
    s_waitcnt lgkmcnt(2)
    v_mfma_f32_32x32x16_bf16 v[64:79], v[52:55], v[40:43], v[64:79]
    ds_read_b128 v[36:39], v10 offset:16384
    ds_read_b64_tr_b16 v[44:45], v14 offset:32768
    ds_read_b64_tr_b16 v[46:47], v14 offset:33280
    v_mfma_f32_16x16x32_bf16 v[24:27], v[20:23], v[40:43], v[24:27]
    s_waitcnt lgkmcnt(3)
    v_mfma_f32_32x32x16_bf16 v[80:95], v[40:43], v[56:59], v[80:95]
    ds_read_b64_tr_b16 v[48:49], v14 offset:33792
    ds_read_b64_tr_b16 v[50:51], v14 offset:34304
    v_dot2c_f32_bf16 v6, v40, v40
    v_dot2c_f32_bf16 v6, v41, v41
    v_dot2c_f32_bf16 v6, v42, v42
    v_dot2c_f32_bf16 v6, v43, v43
    s_waitcnt lgkmcnt(2)
    v_mfma_f32_32x32x16_bf16 v[64:79], v[44:47], v[36:39], v[64:79]
    ds_read_b128 v[40:43], v11 offset:16384
    ds_read_b64_tr_b16 v[52:53], v15 offset:32768
    ds_read_b64_tr_b16 v[54:55], v15 offset:33280
    v_mfma_f32_16x16x32_bf16 v[24:27], v[20:23], v[36:39], v[24:27]
    s_waitcnt lgkmcnt(3)
    v_mfma_f32_32x32x16_bf16 v[80:95], v[36:39], v[48:51], v[80:95]
    ds_read_b64_tr_b16 v[56:57], v15 offset:33792
    ds_read_b64_tr_b16 v[58:59], v15 offset:34304
    v_dot2c_f32_bf16 v6, v36, v36
    v_dot2c_f32_bf16 v6, v37, v37
    v_dot2c_f32_bf16 v6, v38, v38
    v_dot2c_f32_bf16 v6, v39, v39
    s_barrier
    s_waitcnt lgkmcnt(2)
    v_mfma_f32_32x32x16_bf16 v[64:79], v[52:55], v[40:43], v[64:79]
    ds_read_b128 v[36:39], v8 offset:24576
    ds_read_b64_tr_b16 v[44:45], v12 offset:49152
    ds_read_b64_tr_b16 v[46:47], v12 offset:49664
    v_mfma_f32_16x16x32_bf16 v[28:31], v[20:23], v[52:55], v[28:31]
    s_waitcnt lgkmcnt(3)
    v_mfma_f32_32x32x16_bf16 v[80:95], v[40:43], v[56:59], v[80:95]
    ds_read_b64_tr_b16 v[48:49], v12 offset:50176
    ds_read_b64_tr_b16 v[50:51], v12 offset:50688
    v_mfma_f32_16x16x32_bf16 v[32:35], v[20:23], v[56:59], v[32:35]
    s_waitcnt lgkmcnt(2)
    v_mfma_f32_32x32x16_bf16 v[64:79], v[44:47], v[36:39], v[64:79]
    ds_read_b128 v[40:43], v9 offset:24576
    ds_read_b64_tr_b16 v[52:53], v13 offset:49152
    ds_read_b64_tr_b16 v[54:55], v13 offset:49664
    v_mfma_f32_16x16x32_bf16 v[28:31], v[20:23], v[44:47], v[28:31]
    s_waitcnt lgkmcnt(3)
    v_mfma_f32_32x32x16_bf16 v[80:95], v[36:39], v[48:51], v[80:95]
    ds_read_b64_tr_b16 v[56:57], v13 offset:50176
    ds_read_b64_tr_b16 v[58:59], v13 offset:50688
    v_mfma_f32_16x16x32_bf16 v[32:35], v[20:23], v[48:51], v[32:35]
    s_waitcnt lgkmcnt(2)
    v_mfma_f32_32x32x16_bf16 v[64:79], v[52:55], v[40:43], v[64:79]
    ds_read_b128 v[36:39], v10 offset:24576
    ds_read_b64_tr_b16 v[44:45], v14 offset:49152
    ds_read_b64_tr_b16 v[46:47], v14 offset:49664
    v_mfma_f32_16x16x32_bf16 v[24:27], v[20:23], v[40:43], v[24:27]
    s_waitcnt lgkmcnt(3)
    v_mfma_f32_32x32x16_bf16 v[80:95], v[40:43], v[56:59], v[80:95]
    ds_read_b64_tr_b16 v[48:49], v14 offset:50176
    ds_read_b64_tr_b16 v[50:51], v14 offset:50688
    v_dot2c_f32_bf16 v6, v40, v40
    v_dot2c_f32_bf16 v6, v41, v41
    v_dot2c_f32_bf16 v6, v42, v42
    v_dot2c_f32_bf16 v6, v43, v43
    s_waitcnt lgkmcnt(2)
    v_mfma_f32_32x32x16_bf16 v[64:79], v[44:47], v[36:39], v[64:79]
    ds_read_b128 v[40:43], v11 offset:24576
    ds_read_b64_tr_b16 v[52:53], v15 offset:49152
    ds_read_b64_tr_b16 v[54:55], v15 offset:49664
    v_mfma_f32_16x16x32_bf16 v[24:27], v[20:23], v[36:39], v[24:27]
    s_waitcnt lgkmcnt(3)
    v_mfma_f32_32x32x16_bf16 v[80:95], v[36:39], v[48:51], v[80:95]
    ds_read_b64_tr_b16 v[56:57], v15 offset:50176
    ds_read_b64_tr_b16 v[58:59], v15 offset:50688
    v_dot2c_f32_bf16 v6, v36, v36
    v_dot2c_f32_bf16 v6, v37, v37
    v_dot2c_f32_bf16 v6, v38, v38
    v_dot2c_f32_bf16 v6, v39, v39
    s_barrier
    s_waitcnt lgkmcnt(2)
    v_mfma_f32_32x32x16_bf16 v[64:79], v[52:55], v[40:43], v[64:79]
    ds_read_b128 v[36:39], v8 offset:32768
    ds_read_b64_tr_b16 v[44:45], v12 offset:0
    ds_read_b64_tr_b16 v[46:47], v12 offset:512
    v_mfma_f32_16x16x32_bf16 v[28:31], v[20:23], v[52:55], v[28:31]
    s_waitcnt lgkmcnt(3)
    v_mfma_f32_32x32x16_bf16 v[80:95], v[40:43], v[56:59], v[80:95]
    ds_read_b64_tr_b16 v[48:49], v12 offset:1024
    ds_read_b64_tr_b16 v[50:51], v12 offset:1536
    v_mfma_f32_16x16x32_bf16 v[32:35], v[20:23], v[56:59], v[32:35]
    s_waitcnt lgkmcnt(2)
    v_mfma_f32_32x32x16_bf16 v[64:79], v[44:47], v[36:39], v[64:79]
    ds_read_b128 v[40:43], v9 offset:32768
    ds_read_b64_tr_b16 v[52:53], v13 offset:0
    ds_read_b64_tr_b16 v[54:55], v13 offset:512
    v_mfma_f32_16x16x32_bf16 v[28:31], v[20:23], v[44:47], v[28:31]
    s_waitcnt lgkmcnt(3)
    v_mfma_f32_32x32x16_bf16 v[80:95], v[36:39], v[48:51], v[80:95]
    ds_read_b64_tr_b16 v[56:57], v13 offset:1024
    ds_read_b64_tr_b16 v[58:59], v13 offset:1536
    v_mfma_f32_16x16x32_bf16 v[32:35], v[20:23], v[48:51], v[32:35]
    s_waitcnt lgkmcnt(2)
    v_mfma_f32_32x32x16_bf16 v[64:79], v[52:55], v[40:43], v[64:79]
    ds_read_b128 v[36:39], v10 offset:32768
    ds_read_b64_tr_b16 v[44:45], v14 offset:0
    ds_read_b64_tr_b16 v[46:47], v14 offset:512
    v_mfma_f32_16x16x32_bf16 v[24:27], v[20:23], v[40:43], v[24:27]
    s_waitcnt lgkmcnt(3)
    v_mfma_f32_32x32x16_bf16 v[80:95], v[40:43], v[56:59], v[80:95]
    ds_read_b64_tr_b16 v[48:49], v14 offset:1024
    ds_read_b64_tr_b16 v[50:51], v14 offset:1536
    v_dot2c_f32_bf16 v6, v40, v40
    v_dot2c_f32_bf16 v6, v41, v41
    v_dot2c_f32_bf16 v6, v42, v42
    v_dot2c_f32_bf16 v6, v43, v43
    s_waitcnt lgkmcnt(2)
    v_mfma_f32_32x32x16_bf16 v[64:79], v[44:47], v[36:39], v[64:79]
    ds_read_b128 v[40:43], v11 offset:32768
    ds_read_b64_tr_b16 v[52:53], v15 offset:0
    ds_read_b64_tr_b16 v[54:55], v15 offset:512
    v_mfma_f32_16x16x32_bf16 v[24:27], v[20:23], v[36:39], v[24:27]
    s_waitcnt lgkmcnt(3)
    v_mfma_f32_32x32x16_bf16 v[80:95], v[36:39], v[48:51], v[80:95]
    ds_read_b64_tr_b16 v[56:57], v15 offset:1024
    ds_read_b64_tr_b16 v[58:59], v15 offset:1536
    v_dot2c_f32_bf16 v6, v36, v36
    v_dot2c_f32_bf16 v6, v37, v37
    v_dot2c_f32_bf16 v6, v38, v38
    v_dot2c_f32_bf16 v6, v39, v39
    s_barrier
    s_waitcnt lgkmcnt(2)
    v_mfma_f32_32x32x16_bf16 v[64:79], v[52:55], v[40:43], v[64:79]
    ds_read_b128 v[36:39], v8 offset:40960
    ds_read_b64_tr_b16 v[44:45], v12 offset:16384
    ds_read_b64_tr_b16 v[46:47], v12 offset:16896
    v_mfma_f32_16x16x32_bf16 v[28:31], v[20:23], v[52:55], v[28:31]
    s_waitcnt lgkmcnt(3)
    v_mfma_f32_32x32x16_bf16 v[80:95], v[40:43], v[56:59], v[80:95]
    ds_read_b64_tr_b16 v[48:49], v12 offset:17408
    ds_read_b64_tr_b16 v[50:51], v12 offset:17920
    v_mfma_f32_16x16x32_bf16 v[32:35], v[20:23], v[56:59], v[32:35]
    s_waitcnt lgkmcnt(2)
    v_mfma_f32_32x32x16_bf16 v[64:79], v[44:47], v[36:39], v[64:79]
    ds_read_b128 v[40:43], v9 offset:40960
    ds_read_b64_tr_b16 v[52:53], v13 offset:16384
    ds_read_b64_tr_b16 v[54:55], v13 offset:16896
    v_mfma_f32_16x16x32_bf16 v[28:31], v[20:23], v[44:47], v[28:31]
    s_waitcnt lgkmcnt(3)
    v_mfma_f32_32x32x16_bf16 v[80:95], v[36:39], v[48:51], v[80:95]
    ds_read_b64_tr_b16 v[56:57], v13 offset:17408
    ds_read_b64_tr_b16 v[58:59], v13 offset:17920
    v_mfma_f32_16x16x32_bf16 v[32:35], v[20:23], v[48:51], v[32:35]
    s_waitcnt lgkmcnt(2)
    v_mfma_f32_32x32x16_bf16 v[64:79], v[52:55], v[40:43], v[64:79]
    ds_read_b128 v[36:39], v10 offset:40960
    ds_read_b64_tr_b16 v[44:45], v14 offset:16384
    ds_read_b64_tr_b16 v[46:47], v14 offset:16896
    v_mfma_f32_16x16x32_bf16 v[24:27], v[20:23], v[40:43], v[24:27]
    s_waitcnt lgkmcnt(3)
    v_mfma_f32_32x32x16_bf16 v[80:95], v[40:43], v[56:59], v[80:95]
    ds_read_b64_tr_b16 v[48:49], v14 offset:17408
    ds_read_b64_tr_b16 v[50:51], v14 offset:17920
    v_dot2c_f32_bf16 v6, v40, v40
    v_dot2c_f32_bf16 v6, v41, v41
    v_dot2c_f32_bf16 v6, v42, v42
    v_dot2c_f32_bf16 v6, v43, v43
    s_waitcnt lgkmcnt(2)
    v_mfma_f32_32x32x16_bf16 v[64:79], v[44:47], v[36:39], v[64:79]
    ds_read_b128 v[40:43], v11 offset:40960
    ds_read_b64_tr_b16 v[52:53], v15 offset:16384
    ds_read_b64_tr_b16 v[54:55], v15 offset:16896
    v_mfma_f32_16x16x32_bf16 v[24:27], v[20:23], v[36:39], v[24:27]
    s_waitcnt lgkmcnt(3)
    v_mfma_f32_32x32x16_bf16 v[80:95], v[36:39], v[48:51], v[80:95]
    ds_read_b64_tr_b16 v[56:57], v15 offset:17408
    ds_read_b64_tr_b16 v[58:59], v15 offset:17920
    v_dot2c_f32_bf16 v6, v36, v36
    v_dot2c_f32_bf16 v6, v37, v37
    v_dot2c_f32_bf16 v6, v38, v38
    v_dot2c_f32_bf16 v6, v39, v39
    s_barrier
    s_waitcnt lgkmcnt(2)
    v_mfma_f32_32x32x16_bf16 v[64:79], v[52:55], v[40:43], v[64:79]
    ds_read_b128 v[36:39], v8 offset:49152
    ds_read_b64_tr_b16 v[44:45], v12 offset:32768
    ds_read_b64_tr_b16 v[46:47], v12 offset:33280
    v_mfma_f32_16x16x32_bf16 v[28:31], v[20:23], v[52:55], v[28:31]
    s_waitcnt lgkmcnt(3)
    v_mfma_f32_32x32x16_bf16 v[80:95], v[40:43], v[56:59], v[80:95]
    ds_read_b64_tr_b16 v[48:49], v12 offset:33792
    ds_read_b64_tr_b16 v[50:51], v12 offset:34304
    v_mfma_f32_16x16x32_bf16 v[32:35], v[20:23], v[56:59], v[32:35]
    s_waitcnt lgkmcnt(2)
    v_mfma_f32_32x32x16_bf16 v[64:79], v[44:47], v[36:39], v[64:79]
    ds_read_b128 v[40:43], v9 offset:49152
    ds_read_b64_tr_b16 v[52:53], v13 offset:32768
    ds_read_b64_tr_b16 v[54:55], v13 offset:33280
    v_mfma_f32_16x16x32_bf16 v[28:31], v[20:23], v[44:47], v[28:31]
    s_waitcnt lgkmcnt(3)
    v_mfma_f32_32x32x16_bf16 v[80:95], v[36:39], v[48:51], v[80:95]
    ds_read_b64_tr_b16 v[56:57], v13 offset:33792
    ds_read_b64_tr_b16 v[58:59], v13 offset:34304
    v_mfma_f32_16x16x32_bf16 v[32:35], v[20:23], v[48:51], v[32:35]
    s_waitcnt lgkmcnt(2)
    v_mfma_f32_32x32x16_bf16 v[64:79], v[52:55], v[40:43], v[64:79]
    ds_read_b128 v[36:39], v10 offset:49152
    ds_read_b64_tr_b16 v[44:45], v14 offset:32768
    ds_read_b64_tr_b16 v[46:47], v14 offset:33280
    v_mfma_f32_16x16x32_bf16 v[24:27], v[20:23], v[40:43], v[24:27]
    s_waitcnt lgkmcnt(3)
    v_mfma_f32_32x32x16_bf16 v[80:95], v[40:43], v[56:59], v[80:95]
    ds_read_b64_tr_b16 v[48:49], v14 offset:33792
    ds_read_b64_tr_b16 v[50:51], v14 offset:34304
    v_dot2c_f32_bf16 v6, v40, v40
    v_dot2c_f32_bf16 v6, v41, v41
    v_dot2c_f32_bf16 v6, v42, v42
    v_dot2c_f32_bf16 v6, v43, v43
    s_waitcnt lgkmcnt(2)
    v_mfma_f32_32x32x16_bf16 v[64:79], v[44:47], v[36:39], v[64:79]
    ds_read_b128 v[40:43], v11 offset:49152
    ds_read_b64_tr_b16 v[52:53], v15 offset:32768
    ds_read_b64_tr_b16 v[54:55], v15 offset:33280
    v_mfma_f32_16x16x32_bf16 v[24:27], v[20:23], v[36:39], v[24:27]
    s_waitcnt lgkmcnt(3)
    v_mfma_f32_32x32x16_bf16 v[80:95], v[36:39], v[48:51], v[80:95]
    ds_read_b64_tr_b16 v[56:57], v15 offset:33792
    ds_read_b64_tr_b16 v[58:59], v15 offset:34304
    v_dot2c_f32_bf16 v6, v36, v36
    v_dot2c_f32_bf16 v6, v37, v37
    v_dot2c_f32_bf16 v6, v38, v38
    v_dot2c_f32_bf16 v6, v39, v39
    s_barrier
    s_waitcnt lgkmcnt(2)
    v_mfma_f32_32x32x16_bf16 v[64:79], v[52:55], v[40:43], v[64:79]
    ds_read_b128 v[36:39], v8 offset:57344
    ds_read_b64_tr_b16 v[44:45], v12 offset:49152
    ds_read_b64_tr_b16 v[46:47], v12 offset:49664
    v_mfma_f32_16x16x32_bf16 v[28:31], v[20:23], v[52:55], v[28:31]
    s_waitcnt lgkmcnt(3)
    v_mfma_f32_32x32x16_bf16 v[80:95], v[40:43], v[56:59], v[80:95]
    ds_read_b64_tr_b16 v[48:49], v12 offset:50176
    ds_read_b64_tr_b16 v[50:51], v12 offset:50688
    v_mfma_f32_16x16x32_bf16 v[32:35], v[20:23], v[56:59], v[32:35]
    s_waitcnt lgkmcnt(2)
    v_mfma_f32_32x32x16_bf16 v[64:79], v[44:47], v[36:39], v[64:79]
    ds_read_b128 v[40:43], v9 offset:57344
    ds_read_b64_tr_b16 v[52:53], v13 offset:49152
    ds_read_b64_tr_b16 v[54:55], v13 offset:49664
    v_mfma_f32_16x16x32_bf16 v[28:31], v[20:23], v[44:47], v[28:31]
    s_waitcnt lgkmcnt(3)
    v_mfma_f32_32x32x16_bf16 v[80:95], v[36:39], v[48:51], v[80:95]
    ds_read_b64_tr_b16 v[56:57], v13 offset:50176
    ds_read_b64_tr_b16 v[58:59], v13 offset:50688
    v_mfma_f32_16x16x32_bf16 v[32:35], v[20:23], v[48:51], v[32:35]
    s_waitcnt lgkmcnt(2)
    v_mfma_f32_32x32x16_bf16 v[64:79], v[52:55], v[40:43], v[64:79]
    ds_read_b128 v[36:39], v10 offset:57344
    ds_read_b64_tr_b16 v[44:45], v14 offset:49152
    ds_read_b64_tr_b16 v[46:47], v14 offset:49664
    v_mfma_f32_16x16x32_bf16 v[24:27], v[20:23], v[40:43], v[24:27]
    s_waitcnt lgkmcnt(3)
    v_mfma_f32_32x32x16_bf16 v[80:95], v[40:43], v[56:59], v[80:95]
    ds_read_b64_tr_b16 v[48:49], v14 offset:50176
    ds_read_b64_tr_b16 v[50:51], v14 offset:50688
    v_dot2c_f32_bf16 v6, v40, v40
    v_dot2c_f32_bf16 v6, v41, v41
    v_dot2c_f32_bf16 v6, v42, v42
    v_dot2c_f32_bf16 v6, v43, v43
    s_waitcnt lgkmcnt(2)
    v_mfma_f32_32x32x16_bf16 v[64:79], v[44:47], v[36:39], v[64:79]
    ds_read_b128 v[40:43], v11 offset:57344
    ds_read_b64_tr_b16 v[52:53], v15 offset:49152
    ds_read_b64_tr_b16 v[54:55], v15 offset:49664
    v_mfma_f32_16x16x32_bf16 v[24:27], v[20:23], v[36:39], v[24:27]
    s_waitcnt lgkmcnt(3)
    v_mfma_f32_32x32x16_bf16 v[80:95], v[36:39], v[48:51], v[80:95]
    ds_read_b64_tr_b16 v[56:57], v15 offset:50176
    ds_read_b64_tr_b16 v[58:59], v15 offset:50688
    v_dot2c_f32_bf16 v6, v36, v36
    v_dot2c_f32_bf16 v6, v37, v37
    v_dot2c_f32_bf16 v6, v38, v38
    v_dot2c_f32_bf16 v6, v39, v39
    s_waitcnt lgkmcnt(2)
    v_mfma_f32_32x32x16_bf16 v[64:79], v[52:55], v[40:43], v[64:79]
    v_mfma_f32_16x16x32_bf16 v[28:31], v[20:23], v[52:55], v[28:31]
    s_waitcnt lgkmcnt(0)
    v_mfma_f32_32x32x16_bf16 v[80:95], v[40:43], v[56:59], v[80:95]
    v_mfma_f32_16x16x32_bf16 v[32:35], v[20:23], v[56:59], v[32:35]
    s_xor_b32 s70, s66, 1
    s_lshl_b32 s70, s70, 13
    s_add_u32 s70, s70, 135168
    v_lshl_add_u32 v36, v0, 2, s70
    s_xor_b32 s70, s66, 2
    s_lshl_b32 s70, s70, 13
    s_add_u32 s70, s70, 135168
    v_lshl_add_u32 v37, v0, 2, s70
    s_lshl_b32 s70, s66, 13
    s_add_u32 s70, s70, 135168
    v_lshl_add_u32 v38, v0, 2, s70
    ds_write_b32 v37, v6 offset:768
    ds_write_b32 v37, v24 offset:512
    ds_write_b32 v36, v28
    ds_write_b32 v36, v32 offset:256
    s_add_u32 s70, s70, 1024
    v_lshl_add_u32 v39, v1, 2, s70
    v_lshl_add_u32 v40, v2, 4, s70
    s_mov_b64 exec, 3
    ds_add_u32 v110, v111 offset:4
    s_mov_b64 exec, -1
CW13:
    ds_read_b32 v62, v110 offset:4
    s_sub_u32 s5, s5, 1
    s_cmp_lt_i32 s5, 0
    s_cbranch_scc1 CE14
    s_waitcnt lgkmcnt(0)
    v_readfirstlane_b32 s3, v62
    s_nop 0
    s_cmp_lt_u32 s3, 4
    s_cbranch_scc1 CW13
CE14:
    ds_read2st64_b32 v[44:45], v38 offset0:2 offset1:3
    ds_read2st64_b32 v[46:47], v38 offset0:0 offset1:1
    v_cmp_gt_u32 vcc, 32, v0
    s_waitcnt lgkmcnt(1)
    v_add_f32 v24, v24, v44
    v_add_f32 v6, v6, v45
    v_mov_b32 v50, v6
    s_nop 1
    v_permlane32_swap_b32 v6, v50
    v_add_f32 v6, v6, v50
    v_mul_f32 v48, s32, v24
    v_mul_f32 v50, v48, v48
    v_fma_f32 v50, v6, s32, -v50
    v_max_f32 v50, 0, v50
    v_add_f32 v50, s33, v50
    v_rsq_f32 v49, v50
    v_sub_f32 v48, 0, v48
    ds_write_b32 v39, v49
    v_cvt_pk_bf16_f32 v105, v48, 0
    v_lshlrev_b32 v50, 16, v105
    v_sub_f32 v50, v48, v50
    v_cvt_pk_bf16_f32 v104, v48, v50
    v_mov_b32 v106, 0
    v_mov_b32 v107, 0
    s_waitcnt lgkmcnt(0)
    ds_read_b128 v[128:131], v40 offset:0
    ds_read_b128 v[132:135], v40 offset:32
    ds_read_b128 v[136:139], v40 offset:64
    ds_read_b128 v[140:143], v40 offset:96
    v_add_f32 v28, v28, v46
    v_cndmask_b32 v28, 0, v28, vcc
    v_cvt_pk_bf16_f32 v52, v28, v28
    v_lshlrev_b32 v50, 16, v52
    v_sub_f32 v50, v28, v50
    v_cvt_pk_bf16_f32 v53, v50, 0
    v_mov_b32 v54, 0
    v_mov_b32 v55, 0
    s_nop 1
    v_mfma_f32_32x32x16_bf16 v[64:79], v[52:55], v[104:107], v[64:79]
    v_add_f32 v32, v32, v47
    v_cndmask_b32 v32, 0, v32, vcc
    v_cvt_pk_bf16_f32 v56, v32, v32
    v_lshlrev_b32 v50, 16, v56
    v_sub_f32 v50, v32, v50
    v_cvt_pk_bf16_f32 v57, v50, 0
    v_mov_b32 v58, 0
    v_mov_b32 v59, 0
    s_nop 1
    v_mfma_f32_32x32x16_bf16 v[80:95], v[104:107], v[56:59], v[80:95]
    v_mul_f32 v108, s34, v49
    v_pk_mul_f32 v[64:65], v[64:65], v[108:109] op_sel_hi:[1,0]
    v_pk_mul_f32 v[66:67], v[66:67], v[108:109] op_sel_hi:[1,0]
    v_pk_mul_f32 v[68:69], v[68:69], v[108:109] op_sel_hi:[1,0]
    v_pk_mul_f32 v[70:71], v[70:71], v[108:109] op_sel_hi:[1,0]
    v_pk_mul_f32 v[72:73], v[72:73], v[108:109] op_sel_hi:[1,0]
    v_pk_mul_f32 v[74:75], v[74:75], v[108:109] op_sel_hi:[1,0]
    v_pk_mul_f32 v[76:77], v[76:77], v[108:109] op_sel_hi:[1,0]
    v_pk_mul_f32 v[78:79], v[78:79], v[108:109] op_sel_hi:[1,0]
    v_cvt_pk_bf16_f32 v36, v64, v65
    v_cvt_pk_bf16_f32 v37, v66, v67
    v_cvt_pk_bf16_f32 v38, v68, v69
    v_cvt_pk_bf16_f32 v39, v70, v71
    v_cvt_pk_bf16_f32 v40, v72, v73
    v_cvt_pk_bf16_f32 v41, v74, v75
    v_cvt_pk_bf16_f32 v42, v76, v77
    v_cvt_pk_bf16_f32 v43, v78, v79
    v_mfma_f32_32x32x16_bf16 v[144:159], v[120:123], v[36:39], 0
    s_nop 0
    v_mfma_f32_32x32x16_bf16 v[160:175], v[124:127], v[40:43], 0
    s_waitcnt lgkmcnt(0)
    v_pk_mul_f32 v[80:81], v[80:81], v[128:129]
    v_pk_mul_f32 v[82:83], v[82:83], v[130:131]
    v_pk_mul_f32 v[84:85], v[84:85], v[132:133]
    v_pk_mul_f32 v[86:87], v[86:87], v[134:135]
    v_pk_mul_f32 v[88:89], v[88:89], v[136:137]
    v_pk_mul_f32 v[90:91], v[90:91], v[138:139]
    v_pk_mul_f32 v[92:93], v[92:93], v[140:141]
    v_pk_mul_f32 v[94:95], v[94:95], v[142:143]
    v_cvt_pk_bf16_f32 v44, v80, v81
    v_cvt_pk_bf16_f32 v45, v82, v83
    v_cvt_pk_bf16_f32 v46, v84, v85
    v_cvt_pk_bf16_f32 v47, v86, v87
    v_cvt_pk_bf16_f32 v48, v88, v89
    v_cvt_pk_bf16_f32 v49, v90, v91
    v_cvt_pk_bf16_f32 v50, v92, v93
    v_cvt_pk_bf16_f32 v51, v94, v95
    v_and_b32 v60, 16, v0
    v_cmp_eq_u32 vcc, 0, v60
    s_nop 1
    v_cndmask_b32 v52, v5, v44, vcc
    v_cndmask_b32 v53, v5, v45, vcc
    v_cndmask_b32 v54, v5, v46, vcc
    v_cndmask_b32 v55, v5, v47, vcc
    v_cndmask_b32 v56, v5, v48, vcc
    v_cndmask_b32 v57, v5, v49, vcc
    v_cndmask_b32 v58, v5, v50, vcc
    v_cndmask_b32 v59, v5, v51, vcc
    v_cndmask_b32 v176, v44, v5, vcc
    v_cndmask_b32 v177, v45, v5, vcc
    v_cndmask_b32 v178, v46, v5, vcc
    v_cndmask_b32 v179, v47, v5, vcc
    v_cndmask_b32 v180, v48, v5, vcc
    v_cndmask_b32 v181, v49, v5, vcc
    v_cndmask_b32 v182, v50, v5, vcc
    v_cndmask_b32 v183, v51, v5, vcc
    v_max3_f32 v240, v144, v145, v146
    v_max3_f32 v246, v160, v161, v162
    v_max3_f32 v241, v152, v153, v154
    v_max3_f32 v247, v168, v169, v170
    v_max3_f32 v240, v240, v147, v148
    v_max3_f32 v246, v246, v163, v164
    v_max3_f32 v241, v241, v155, v156
    v_max3_f32 v247, v247, v171, v172
    v_max3_f32 v240, v240, v149, v150
    v_max3_f32 v246, v246, v165, v166
    v_max3_f32 v241, v241, v157, v158
    v_max3_f32 v247, v247, v173, v174
    v_max_f32 v240, v240, v151
    v_max_f32 v246, v246, v167
    v_max_f32 v241, v241, v159
    v_max_f32 v247, v247, v175
    s_nop 0
    v_permlane32_swap_b32 v240, v241
    v_permlane32_swap_b32 v246, v247
    v_max_f32 v240, v240, v241
    v_max_f32 v246, v246, v247
    v_mov_b32 v241, v240
    v_mov_b32 v247, v246
    s_nop 0
    v_permlane32_swap_b32 v240, v241
    v_permlane32_swap_b32 v246, v247
    v_pk_add_f32 v[144:145], v[144:145], v[240:241] op_sel_hi:[1,0] neg_lo:[0,1] neg_hi:[0,1]
    v_pk_add_f32 v[160:161], v[160:161], v[246:247] op_sel_hi:[1,0] neg_lo:[0,1] neg_hi:[0,1]
    v_pk_add_f32 v[146:147], v[146:147], v[240:241] op_sel_hi:[1,0] neg_lo:[0,1] neg_hi:[0,1]
    v_pk_add_f32 v[162:163], v[162:163], v[246:247] op_sel_hi:[1,0] neg_lo:[0,1] neg_hi:[0,1]
    v_pk_add_f32 v[148:149], v[148:149], v[240:241] op_sel_hi:[1,0] neg_lo:[0,1] neg_hi:[0,1]
    v_pk_add_f32 v[164:165], v[164:165], v[246:247] op_sel_hi:[1,0] neg_lo:[0,1] neg_hi:[0,1]
    v_pk_add_f32 v[150:151], v[150:151], v[240:241] op_sel_hi:[1,0] neg_lo:[0,1] neg_hi:[0,1]
    v_pk_add_f32 v[166:167], v[166:167], v[246:247] op_sel_hi:[1,0] neg_lo:[0,1] neg_hi:[0,1]
    v_pk_add_f32 v[152:153], v[152:153], v[240:241] op_sel:[0,1] op_sel_hi:[1,1] neg_lo:[0,1] neg_hi:[0,1]
    v_pk_add_f32 v[168:169], v[168:169], v[246:247] op_sel:[0,1] op_sel_hi:[1,1] neg_lo:[0,1] neg_hi:[0,1]
    v_pk_add_f32 v[154:155], v[154:155], v[240:241] op_sel:[0,1] op_sel_hi:[1,1] neg_lo:[0,1] neg_hi:[0,1]
    v_pk_add_f32 v[170:171], v[170:171], v[246:247] op_sel:[0,1] op_sel_hi:[1,1] neg_lo:[0,1] neg_hi:[0,1]
    v_pk_add_f32 v[156:157], v[156:157], v[240:241] op_sel:[0,1] op_sel_hi:[1,1] neg_lo:[0,1] neg_hi:[0,1]
    v_pk_add_f32 v[172:173], v[172:173], v[246:247] op_sel:[0,1] op_sel_hi:[1,1] neg_lo:[0,1] neg_hi:[0,1]
    v_pk_add_f32 v[158:159], v[158:159], v[240:241] op_sel:[0,1] op_sel_hi:[1,1] neg_lo:[0,1] neg_hi:[0,1]
    v_pk_add_f32 v[174:175], v[174:175], v[246:247] op_sel:[0,1] op_sel_hi:[1,1] neg_lo:[0,1] neg_hi:[0,1]
    v_exp_f32 v144, v144
    v_exp_f32 v160, v160
    v_exp_f32 v145, v145
    v_exp_f32 v161, v161
    v_exp_f32 v146, v146
    v_exp_f32 v162, v162
    v_exp_f32 v147, v147
    v_exp_f32 v163, v163
    v_exp_f32 v148, v148
    v_exp_f32 v164, v164
    v_exp_f32 v149, v149
    v_exp_f32 v165, v165
    v_exp_f32 v150, v150
    v_exp_f32 v166, v166
    v_exp_f32 v151, v151
    v_exp_f32 v167, v167
    v_exp_f32 v152, v152
    v_exp_f32 v168, v168
    v_exp_f32 v153, v153
    v_exp_f32 v169, v169
    v_exp_f32 v154, v154
    v_exp_f32 v170, v170
    v_exp_f32 v155, v155
    v_exp_f32 v171, v171
    v_exp_f32 v156, v156
    v_exp_f32 v172, v172
    v_exp_f32 v157, v157
    v_exp_f32 v173, v173
    v_exp_f32 v158, v158
    v_exp_f32 v174, v174
    v_exp_f32 v159, v159
    v_exp_f32 v175, v175
    v_pk_add_f32 v[242:243], v[144:145], v[146:147]
    v_pk_add_f32 v[248:249], v[160:161], v[162:163]
    v_pk_add_f32 v[244:245], v[148:149], v[150:151]
    v_pk_add_f32 v[250:251], v[164:165], v[166:167]
    v_pk_add_f32 v[242:243], v[242:243], v[244:245]
    v_pk_add_f32 v[248:249], v[248:249], v[250:251]
    v_add_f32 v240, v242, v243
    v_add_f32 v246, v248, v249
    v_pk_add_f32 v[242:243], v[152:153], v[154:155]
    v_pk_add_f32 v[248:249], v[168:169], v[170:171]
    v_pk_add_f32 v[244:245], v[156:157], v[158:159]
    v_pk_add_f32 v[250:251], v[172:173], v[174:175]
    v_pk_add_f32 v[242:243], v[242:243], v[244:245]
    v_pk_add_f32 v[248:249], v[248:249], v[250:251]
    v_add_f32 v241, v242, v243
    v_add_f32 v247, v248, v249
    s_nop 0
    v_permlane32_swap_b32 v240, v241
    v_permlane32_swap_b32 v246, v247
    v_add_f32 v240, v240, v241
    v_add_f32 v246, v246, v247
    v_mov_b32 v241, v240
    v_mov_b32 v247, v246
    s_nop 0
    v_permlane32_swap_b32 v240, v241
    v_permlane32_swap_b32 v246, v247
    v_rcp_f32 v240, v240
    v_rcp_f32 v246, v246
    v_rcp_f32 v241, v241
    v_rcp_f32 v247, v247
    v_pk_mul_f32 v[144:145], v[144:145], v[240:241] op_sel_hi:[1,0]
    v_pk_mul_f32 v[160:161], v[160:161], v[246:247] op_sel_hi:[1,0]
    v_pk_mul_f32 v[146:147], v[146:147], v[240:241] op_sel_hi:[1,0]
    v_pk_mul_f32 v[162:163], v[162:163], v[246:247] op_sel_hi:[1,0]
    v_pk_mul_f32 v[148:149], v[148:149], v[240:241] op_sel_hi:[1,0]
    v_pk_mul_f32 v[164:165], v[164:165], v[246:247] op_sel_hi:[1,0]
    v_pk_mul_f32 v[150:151], v[150:151], v[240:241] op_sel_hi:[1,0]
    v_pk_mul_f32 v[166:167], v[166:167], v[246:247] op_sel_hi:[1,0]
    v_pk_mul_f32 v[152:153], v[152:153], v[240:241] op_sel:[0,1] op_sel_hi:[1,1]
    v_pk_mul_f32 v[168:169], v[168:169], v[246:247] op_sel:[0,1] op_sel_hi:[1,1]
    v_pk_mul_f32 v[154:155], v[154:155], v[240:241] op_sel:[0,1] op_sel_hi:[1,1]
    v_pk_mul_f32 v[170:171], v[170:171], v[246:247] op_sel:[0,1] op_sel_hi:[1,1]
    v_pk_mul_f32 v[156:157], v[156:157], v[240:241] op_sel:[0,1] op_sel_hi:[1,1]
    v_pk_mul_f32 v[172:173], v[172:173], v[246:247] op_sel:[0,1] op_sel_hi:[1,1]
    v_pk_mul_f32 v[158:159], v[158:159], v[240:241] op_sel:[0,1] op_sel_hi:[1,1]
    v_pk_mul_f32 v[174:175], v[174:175], v[246:247] op_sel:[0,1] op_sel_hi:[1,1]
    v_cvt_pk_bf16_f32 v192, v144, v145
    v_cvt_pk_bf16_f32 v200, v160, v161
    v_cvt_pk_bf16_f32 v193, v146, v147
    v_cvt_pk_bf16_f32 v201, v162, v163
    v_cvt_pk_bf16_f32 v194, v148, v149
    v_cvt_pk_bf16_f32 v202, v164, v165
    v_cvt_pk_bf16_f32 v195, v150, v151
    v_cvt_pk_bf16_f32 v203, v166, v167
    v_cvt_pk_bf16_f32 v196, v152, v153
    v_cvt_pk_bf16_f32 v204, v168, v169
    v_cvt_pk_bf16_f32 v197, v154, v155
    v_cvt_pk_bf16_f32 v205, v170, v171
    v_cvt_pk_bf16_f32 v198, v156, v157
    v_cvt_pk_bf16_f32 v206, v172, v173
    v_cvt_pk_bf16_f32 v199, v158, v159
    v_cvt_pk_bf16_f32 v207, v174, v175
    v_mfma_f32_32x32x16_bf16 v[64:79], v[192:195], v[112:115], 0
    v_mfma_f32_32x32x16_bf16 v[64:79], v[196:199], v[116:119], v[64:79]
    v_mfma_f32_32x32x16_bf16 v[80:95], v[200:203], v[112:115], 0
    v_mfma_f32_32x32x16_bf16 v[80:95], v[204:207], v[116:119], v[80:95]
    s_lshl_b32 s70, s66, 13
    s_add_u32 s70, s70, 131072
    v_add_u32 v60, s70, v4
    ds_read_b32 v62, v110 offset:20
    s_waitcnt lgkmcnt(0)
    v_readfirstlane_b32 s4, v62
    s_lshr_b32 s70, s66, 1
    s_lshl_b32 s70, s70, 14
    s_and_b32 s71, s66, 1
    s_mul_i32 s72, s71, 4352
    s_add_u32 s72, s72, s70
    s_add_u32 s72, s72, 131072
    v_lshl_add_u32 v61, v0, 2, s72
    s_mul_i32 s72, s71, 3840
    s_add_u32 s72, s72, s70
    s_add_u32 s72, s72, 131328
    v_bfe_u32 v101, v0, 2, 3
    v_lshlrev_b32 v101, 9, v101
    v_and_b32 v3, 3, v0
    v_lshl_add_u32 v101, v3, 2, v101
    v_add_u32 v101, s72, v101
    v_cvt_pk_bf16_f32 v36, v64, v65
    v_cvt_pk_bf16_f32 v37, v66, v67
    v_cvt_pk_bf16_f32 v38, v68, v69
    v_cvt_pk_bf16_f32 v39, v70, v71
    v_cvt_pk_bf16_f32 v40, v72, v73
    v_cvt_pk_bf16_f32 v41, v74, v75
    v_cvt_pk_bf16_f32 v42, v76, v77
    v_cvt_pk_bf16_f32 v43, v78, v79
    v_mfma_f32_32x32x16_bf16 v[208:223], v[36:39], v[52:55], 0
    s_nop 0
    v_mfma_f32_32x32x16_bf16 v[208:223], v[40:43], v[56:59], v[208:223]
    v_cvt_pk_bf16_f32 v44, v80, v81
    v_cvt_pk_bf16_f32 v45, v82, v83
    v_cvt_pk_bf16_f32 v46, v84, v85
    v_cvt_pk_bf16_f32 v47, v86, v87
    v_cvt_pk_bf16_f32 v48, v88, v89
    v_cvt_pk_bf16_f32 v49, v90, v91
    v_cvt_pk_bf16_f32 v50, v92, v93
    v_cvt_pk_bf16_f32 v51, v94, v95
    v_mfma_f32_32x32x16_bf16 v[224:239], v[44:47], v[176:179], 0
    s_nop 0
    v_mfma_f32_32x32x16_bf16 v[224:239], v[48:51], v[180:183], v[224:239]
    s_mov_b32 s76, s22
    s_lshl_b32 s70, s62, 3
    s_add_u32 s70, s70, s63
    s_lshl_b32 s70, s70, 2
    s_add_u32 s70, s70, s66
    s_mul_i32 s77, s70, 3072
    s_add_u32 s77, s77, 6291456
    s_xor_b32 s70, s76, s66
    s_cmp_eq_u32 s70, 1
    s_cselect_b32 s70, s67, 0
    s_mul_i32 s70, s70, 3072
    s_sub_u32 s77, s77, s70
    v_mov_b32 v67, s69
    v_mov_b32 v71, s69
    v_mov_b32 v75, s69
    s_mov_b32 exec_lo, 0x1ffff
    s_mov_b32 exec_hi, 0x1ffff
    ds_write_b128 v60, v[208:211] offset:0
    ds_write_b128 v60, v[212:215] offset:1024
    ds_write_b128 v60, v[216:219] offset:2048
    ds_write_b128 v60, v[220:223] offset:3072
    s_mov_b32 exec_lo, 0xffff0001
    s_mov_b32 exec_hi, 0xffff0001
    ds_write_b128 v60, v[224:227] offset:4096
    ds_write_b128 v60, v[228:231] offset:5120
    ds_write_b128 v60, v[232:235] offset:6144
    ds_write_b128 v60, v[236:239] offset:7168
    s_mov_b64 exec, 3
    ds_add_u32 v110, v111 offset:12
    s_mov_b64 exec, -1
CW15:
    ds_read_b32 v62, v110 offset:12
    s_sub_u32 s5, s5, 1
    s_cmp_lt_i32 s5, 0
    s_cbranch_scc1 CE16
    s_waitcnt lgkmcnt(0)
    v_readfirstlane_b32 s3, v62
    s_nop 0
    s_cmp_lt_u32 s3, 4
    s_cbranch_scc1 CW15
CE16:
    s_cmp_eq_u32 s76, s66
    s_cbranch_scc1 C_NOPA
    ds_read2st64_b32 v[144:145], v61 offset0:0 offset1:32
    ds_read2st64_b32 v[146:147], v61 offset0:2 offset1:34
    ds_read2st64_b32 v[148:149], v61 offset0:4 offset1:36
    ds_read2st64_b32 v[150:151], v61 offset0:6 offset1:38
    ds_read2st64_b32 v[152:153], v61 offset0:8 offset1:40
    ds_read2st64_b32 v[154:155], v61 offset0:10 offset1:42
    ds_read2st64_b32 v[156:157], v61 offset0:12 offset1:44
    ds_read2st64_b32 v[158:159], v61 offset0:14 offset1:46
    ds_read2st64_b32 v[160:161], v101 offset0:0 offset1:32
    s_waitcnt lgkmcnt(8)
    v_add_f32 v64, v144, v145
    s_waitcnt lgkmcnt(7)
    v_add_f32 v65, v146, v147
    s_waitcnt lgkmcnt(6)
    v_add_f32 v66, v148, v149
    s_waitcnt lgkmcnt(5)
    v_add_f32 v68, v150, v151
    s_waitcnt lgkmcnt(4)
    v_add_f32 v69, v152, v153
    s_waitcnt lgkmcnt(3)
    v_add_f32 v70, v154, v155
    s_waitcnt lgkmcnt(2)
    v_add_f32 v72, v156, v157
    s_waitcnt lgkmcnt(1)
    v_add_f32 v73, v158, v159
    s_waitcnt lgkmcnt(0)
    v_add_f32 v74, v160, v161
    s_cmp_eq_u32 s4, 1
    s_cbranch_scc1 HS17
    buffer_store_dwordx4 v[64:67], v4, s[16:19], s77 offen offset:0 sc1
    buffer_store_dwordx4 v[68:71], v4, s[16:19], s77 offen offset:1024 sc1
    buffer_store_dwordx4 v[72:75], v4, s[16:19], s77 offen offset:2048 sc1
    s_branch HE18
HS17:
    buffer_store_dwordx4 v[64:67], v4, s[16:19], s77 offen offset:0
    buffer_store_dwordx4 v[68:71], v4, s[16:19], s77 offen offset:1024
    buffer_store_dwordx4 v[72:75], v4, s[16:19], s77 offen offset:2048
HE18:
C_NOPA:
CW19:
    ds_read_b32 v62, v110 offset:24
    s_sub_u32 s5, s5, 1
    s_cmp_lt_i32 s5, 0
    s_cbranch_scc1 CE20
    s_waitcnt lgkmcnt(0)
    v_readfirstlane_b32 s3, v62
    s_nop 0
    s_cmp_lt_u32 s3, 2
    s_cbranch_scc1 CW19
CE20:
    ds_read_b128 v[36:39], v8 offset:0
    ds_read_b64_tr_b16 v[44:45], v16 offset:0
    ds_read_b64_tr_b16 v[46:47], v16 offset:512
    ds_read_b128 v[40:43], v9 offset:0
    ds_read_b64_tr_b16 v[48:49], v17 offset:0
    ds_read_b64_tr_b16 v[50:51], v17 offset:512
    ds_read_b128 v[52:55], v10 offset:0
    ds_read_b64_tr_b16 v[56:57], v18 offset:0
    ds_read_b64_tr_b16 v[58:59], v18 offset:512
    s_waitcnt lgkmcnt(6)
    v_mfma_f32_32x32x16_bf16 v[128:143], v[44:47], v[36:39], 0
    v_mfma_f32_16x16x32_bf16 v[28:31], v[20:23], v[44:47], 0
    ds_read_b128 v[36:39], v11 offset:0
    ds_read_b64_tr_b16 v[44:45], v19 offset:0
    ds_read_b64_tr_b16 v[46:47], v19 offset:512
    s_waitcnt lgkmcnt(6)
    v_mfma_f32_32x32x16_bf16 v[128:143], v[48:51], v[40:43], v[128:143]
    v_mfma_f32_16x16x32_bf16 v[28:31], v[20:23], v[48:51], v[28:31]
    ds_read_b128 v[40:43], v8 offset:8192
    ds_read_b64_tr_b16 v[48:49], v16 offset:8192
    ds_read_b64_tr_b16 v[50:51], v16 offset:8704
    s_waitcnt lgkmcnt(6)
    v_mfma_f32_32x32x16_bf16 v[128:143], v[56:59], v[52:55], v[128:143]
    v_mfma_f32_16x16x32_bf16 v[28:31], v[20:23], v[56:59], v[28:31]
    ds_read_b128 v[52:55], v9 offset:8192
    ds_read_b64_tr_b16 v[56:57], v17 offset:8192
    ds_read_b64_tr_b16 v[58:59], v17 offset:8704
    s_waitcnt lgkmcnt(6)
    v_mfma_f32_32x32x16_bf16 v[128:143], v[44:47], v[36:39], v[128:143]
    v_mfma_f32_16x16x32_bf16 v[28:31], v[20:23], v[44:47], v[28:31]
    ds_read_b128 v[36:39], v10 offset:8192
    ds_read_b64_tr_b16 v[44:45], v18 offset:8192
    ds_read_b64_tr_b16 v[46:47], v18 offset:8704
    s_waitcnt lgkmcnt(6)
    v_mfma_f32_32x32x16_bf16 v[128:143], v[48:51], v[40:43], v[128:143]
    v_mfma_f32_16x16x32_bf16 v[28:31], v[20:23], v[48:51], v[28:31]
    ds_read_b128 v[40:43], v11 offset:8192
    ds_read_b64_tr_b16 v[48:49], v19 offset:8192
    ds_read_b64_tr_b16 v[50:51], v19 offset:8704
    s_waitcnt lgkmcnt(6)
    v_mfma_f32_32x32x16_bf16 v[128:143], v[56:59], v[52:55], v[128:143]
    v_mfma_f32_16x16x32_bf16 v[28:31], v[20:23], v[56:59], v[28:31]
    ds_read_b128 v[52:55], v8 offset:16384
    ds_read_b64_tr_b16 v[56:57], v16 offset:16384
    ds_read_b64_tr_b16 v[58:59], v16 offset:16896
    s_waitcnt lgkmcnt(6)
    v_mfma_f32_32x32x16_bf16 v[128:143], v[44:47], v[36:39], v[128:143]
    v_mfma_f32_16x16x32_bf16 v[28:31], v[20:23], v[44:47], v[28:31]
    ds_read_b128 v[36:39], v9 offset:16384
    ds_read_b64_tr_b16 v[44:45], v17 offset:16384
    ds_read_b64_tr_b16 v[46:47], v17 offset:16896
    s_waitcnt lgkmcnt(6)
    v_mfma_f32_32x32x16_bf16 v[128:143], v[48:51], v[40:43], v[128:143]
    v_mfma_f32_16x16x32_bf16 v[28:31], v[20:23], v[48:51], v[28:31]
    ds_read_b128 v[40:43], v10 offset:16384
    ds_read_b64_tr_b16 v[48:49], v18 offset:16384
    ds_read_b64_tr_b16 v[50:51], v18 offset:16896
    s_waitcnt lgkmcnt(6)
    v_mfma_f32_32x32x16_bf16 v[128:143], v[56:59], v[52:55], v[128:143]
    v_mfma_f32_16x16x32_bf16 v[28:31], v[20:23], v[56:59], v[28:31]
    ds_read_b128 v[52:55], v11 offset:16384
    ds_read_b64_tr_b16 v[56:57], v19 offset:16384
    ds_read_b64_tr_b16 v[58:59], v19 offset:16896
    s_waitcnt lgkmcnt(6)
    v_mfma_f32_32x32x16_bf16 v[128:143], v[44:47], v[36:39], v[128:143]
    v_mfma_f32_16x16x32_bf16 v[28:31], v[20:23], v[44:47], v[28:31]
    ds_read_b128 v[36:39], v8 offset:24576
    ds_read_b64_tr_b16 v[44:45], v16 offset:24576
    ds_read_b64_tr_b16 v[46:47], v16 offset:25088
    s_waitcnt lgkmcnt(6)
    v_mfma_f32_32x32x16_bf16 v[128:143], v[48:51], v[40:43], v[128:143]
    v_mfma_f32_16x16x32_bf16 v[28:31], v[20:23], v[48:51], v[28:31]
    ds_read_b128 v[40:43], v9 offset:24576
    ds_read_b64_tr_b16 v[48:49], v17 offset:24576
    ds_read_b64_tr_b16 v[50:51], v17 offset:25088
    s_waitcnt lgkmcnt(6)
    v_mfma_f32_32x32x16_bf16 v[128:143], v[56:59], v[52:55], v[128:143]
    v_mfma_f32_16x16x32_bf16 v[28:31], v[20:23], v[56:59], v[28:31]
    ds_read_b128 v[52:55], v10 offset:24576
    ds_read_b64_tr_b16 v[56:57], v18 offset:24576
    ds_read_b64_tr_b16 v[58:59], v18 offset:25088
    s_waitcnt lgkmcnt(6)
    v_mfma_f32_32x32x16_bf16 v[128:143], v[44:47], v[36:39], v[128:143]
    v_mfma_f32_16x16x32_bf16 v[28:31], v[20:23], v[44:47], v[28:31]
    ds_read_b128 v[36:39], v11 offset:24576
    ds_read_b64_tr_b16 v[44:45], v19 offset:24576
    ds_read_b64_tr_b16 v[46:47], v19 offset:25088
    s_waitcnt lgkmcnt(6)
    v_mfma_f32_32x32x16_bf16 v[128:143], v[48:51], v[40:43], v[128:143]
    v_mfma_f32_16x16x32_bf16 v[28:31], v[20:23], v[48:51], v[28:31]
    ds_read_b128 v[40:43], v8 offset:32768
    ds_read_b64_tr_b16 v[48:49], v16 offset:32768
    ds_read_b64_tr_b16 v[50:51], v16 offset:33280
    s_waitcnt lgkmcnt(6)
    v_mfma_f32_32x32x16_bf16 v[128:143], v[56:59], v[52:55], v[128:143]
    v_mfma_f32_16x16x32_bf16 v[28:31], v[20:23], v[56:59], v[28:31]
    ds_read_b128 v[52:55], v9 offset:32768
    ds_read_b64_tr_b16 v[56:57], v17 offset:32768
    ds_read_b64_tr_b16 v[58:59], v17 offset:33280
    s_waitcnt lgkmcnt(6)
    v_mfma_f32_32x32x16_bf16 v[128:143], v[44:47], v[36:39], v[128:143]
    v_mfma_f32_16x16x32_bf16 v[28:31], v[20:23], v[44:47], v[28:31]
    ds_read_b128 v[36:39], v10 offset:32768
    ds_read_b64_tr_b16 v[44:45], v18 offset:32768
    ds_read_b64_tr_b16 v[46:47], v18 offset:33280
    s_waitcnt lgkmcnt(6)
    v_mfma_f32_32x32x16_bf16 v[128:143], v[48:51], v[40:43], v[128:143]
    v_mfma_f32_16x16x32_bf16 v[28:31], v[20:23], v[48:51], v[28:31]
    ds_read_b128 v[40:43], v11 offset:32768
    ds_read_b64_tr_b16 v[48:49], v19 offset:32768
    ds_read_b64_tr_b16 v[50:51], v19 offset:33280
    s_waitcnt lgkmcnt(6)
    v_mfma_f32_32x32x16_bf16 v[128:143], v[56:59], v[52:55], v[128:143]
    v_mfma_f32_16x16x32_bf16 v[28:31], v[20:23], v[56:59], v[28:31]
    ds_read_b128 v[52:55], v8 offset:40960
    ds_read_b64_tr_b16 v[56:57], v16 offset:40960
    ds_read_b64_tr_b16 v[58:59], v16 offset:41472
    s_waitcnt lgkmcnt(6)
    v_mfma_f32_32x32x16_bf16 v[128:143], v[44:47], v[36:39], v[128:143]
    v_mfma_f32_16x16x32_bf16 v[28:31], v[20:23], v[44:47], v[28:31]
    ds_read_b128 v[36:39], v9 offset:40960
    ds_read_b64_tr_b16 v[44:45], v17 offset:40960
    ds_read_b64_tr_b16 v[46:47], v17 offset:41472
    s_waitcnt lgkmcnt(6)
    v_mfma_f32_32x32x16_bf16 v[128:143], v[48:51], v[40:43], v[128:143]
    v_mfma_f32_16x16x32_bf16 v[28:31], v[20:23], v[48:51], v[28:31]
    ds_read_b128 v[40:43], v10 offset:40960
    ds_read_b64_tr_b16 v[48:49], v18 offset:40960
    ds_read_b64_tr_b16 v[50:51], v18 offset:41472
    s_waitcnt lgkmcnt(6)
    v_mfma_f32_32x32x16_bf16 v[128:143], v[56:59], v[52:55], v[128:143]
    v_mfma_f32_16x16x32_bf16 v[28:31], v[20:23], v[56:59], v[28:31]
    ds_read_b128 v[52:55], v11 offset:40960
    ds_read_b64_tr_b16 v[56:57], v19 offset:40960
    ds_read_b64_tr_b16 v[58:59], v19 offset:41472
    s_waitcnt lgkmcnt(6)
    v_mfma_f32_32x32x16_bf16 v[128:143], v[44:47], v[36:39], v[128:143]
    v_mfma_f32_16x16x32_bf16 v[28:31], v[20:23], v[44:47], v[28:31]
    ds_read_b128 v[36:39], v8 offset:49152
    ds_read_b64_tr_b16 v[44:45], v16 offset:49152
    ds_read_b64_tr_b16 v[46:47], v16 offset:49664
    s_waitcnt lgkmcnt(6)
    v_mfma_f32_32x32x16_bf16 v[128:143], v[48:51], v[40:43], v[128:143]
    v_mfma_f32_16x16x32_bf16 v[28:31], v[20:23], v[48:51], v[28:31]
    ds_read_b128 v[40:43], v9 offset:49152
    ds_read_b64_tr_b16 v[48:49], v17 offset:49152
    ds_read_b64_tr_b16 v[50:51], v17 offset:49664
    s_waitcnt lgkmcnt(6)
    v_mfma_f32_32x32x16_bf16 v[128:143], v[56:59], v[52:55], v[128:143]
    v_mfma_f32_16x16x32_bf16 v[28:31], v[20:23], v[56:59], v[28:31]
    ds_read_b128 v[52:55], v10 offset:49152
    ds_read_b64_tr_b16 v[56:57], v18 offset:49152
    ds_read_b64_tr_b16 v[58:59], v18 offset:49664
    s_waitcnt lgkmcnt(6)
    v_mfma_f32_32x32x16_bf16 v[128:143], v[44:47], v[36:39], v[128:143]
    v_mfma_f32_16x16x32_bf16 v[28:31], v[20:23], v[44:47], v[28:31]
    ds_read_b128 v[36:39], v11 offset:49152
    ds_read_b64_tr_b16 v[44:45], v19 offset:49152
    ds_read_b64_tr_b16 v[46:47], v19 offset:49664
    s_waitcnt lgkmcnt(6)
    v_mfma_f32_32x32x16_bf16 v[128:143], v[48:51], v[40:43], v[128:143]
    v_mfma_f32_16x16x32_bf16 v[28:31], v[20:23], v[48:51], v[28:31]
    ds_read_b128 v[40:43], v8 offset:57344
    ds_read_b64_tr_b16 v[48:49], v16 offset:57344
    ds_read_b64_tr_b16 v[50:51], v16 offset:57856
    s_waitcnt lgkmcnt(6)
    v_mfma_f32_32x32x16_bf16 v[128:143], v[56:59], v[52:55], v[128:143]
    v_mfma_f32_16x16x32_bf16 v[28:31], v[20:23], v[56:59], v[28:31]
    ds_read_b128 v[52:55], v9 offset:57344
    ds_read_b64_tr_b16 v[56:57], v17 offset:57344
    ds_read_b64_tr_b16 v[58:59], v17 offset:57856
    s_waitcnt lgkmcnt(6)
    v_mfma_f32_32x32x16_bf16 v[128:143], v[44:47], v[36:39], v[128:143]
    v_mfma_f32_16x16x32_bf16 v[28:31], v[20:23], v[44:47], v[28:31]
    ds_read_b128 v[36:39], v10 offset:57344
    ds_read_b64_tr_b16 v[44:45], v18 offset:57344
    ds_read_b64_tr_b16 v[46:47], v18 offset:57856
    s_waitcnt lgkmcnt(6)
    v_mfma_f32_32x32x16_bf16 v[128:143], v[48:51], v[40:43], v[128:143]
    v_mfma_f32_16x16x32_bf16 v[28:31], v[20:23], v[48:51], v[28:31]
    ds_read_b128 v[40:43], v11 offset:57344
    ds_read_b64_tr_b16 v[48:49], v19 offset:57344
    ds_read_b64_tr_b16 v[50:51], v19 offset:57856
    s_waitcnt lgkmcnt(6)
    v_mfma_f32_32x32x16_bf16 v[128:143], v[56:59], v[52:55], v[128:143]
    v_mfma_f32_16x16x32_bf16 v[28:31], v[20:23], v[56:59], v[28:31]
    s_waitcnt lgkmcnt(3)
    v_mfma_f32_32x32x16_bf16 v[128:143], v[44:47], v[36:39], v[128:143]
    v_mfma_f32_16x16x32_bf16 v[28:31], v[20:23], v[44:47], v[28:31]
    s_waitcnt lgkmcnt(0)
    v_mfma_f32_32x32x16_bf16 v[128:143], v[48:51], v[40:43], v[128:143]
    v_mfma_f32_16x16x32_bf16 v[28:31], v[20:23], v[48:51], v[28:31]
    s_sub_u32 s70, s63, s6
    s_and_b32 s70, s70, 7
    s_lshl_b32 s70, s70, 13
    s_lshl_b32 s71, s67, 12
    s_add_u32 s70, s70, s71
    s_lshl_b32 s71, s68, 2
    v_lshrrev_b32 v3, 1, v1
    v_and_b32 v3, 7, v3
    v_xor_b32 v3, s71, v3
    v_lshlrev_b32 v3, 4, v3
    v_lshl_add_u32 v3, v1, 7, v3
    v_lshl_add_u32 v3, v2, 3, v3
    v_add_u32 v3, s70, v3
    ds_read_b64 v[232:233], v3
    v_xor_b32 v60, 16, v3
    ds_read_b64 v[234:235], v60
    v_xor_b32 v60, 32, v3
    ds_read_b64 v[236:237], v60
    v_xor_b32 v60, 48, v3
    ds_read_b64 v[238:239], v60
    s_waitcnt lgkmcnt(0)
    s_mov_b64 exec, 3
    ds_add_u32 v110, v111 offset:0
    s_mov_b64 exec, -1
    v_cmp_gt_u32 vcc, 32, v0
    s_nop 1
    v_cndmask_b32 v28, 0, v28, vcc
    v_cvt_pk_bf16_f32 v52, v28, v28
    v_lshlrev_b32 v50, 16, v52
    v_sub_f32 v50, v28, v50
    v_cvt_pk_bf16_f32 v53, v50, 0
    v_mov_b32 v54, 0
    v_mov_b32 v55, 0
    s_nop 1
    v_mfma_f32_32x32x16_bf16 v[128:143], v[52:55], v[104:107], v[128:143]
    s_nop 11
    v_pk_mul_f32 v[128:129], v[128:129], v[108:109] op_sel_hi:[1,0]
    v_pk_mul_f32 v[130:131], v[130:131], v[108:109] op_sel_hi:[1,0]
    v_pk_mul_f32 v[132:133], v[132:133], v[108:109] op_sel_hi:[1,0]
    v_pk_mul_f32 v[134:135], v[134:135], v[108:109] op_sel_hi:[1,0]
    v_pk_mul_f32 v[136:137], v[136:137], v[108:109] op_sel_hi:[1,0]
    v_pk_mul_f32 v[138:139], v[138:139], v[108:109] op_sel_hi:[1,0]
    v_pk_mul_f32 v[140:141], v[140:141], v[108:109] op_sel_hi:[1,0]
    v_pk_mul_f32 v[142:143], v[142:143], v[108:109] op_sel_hi:[1,0]
    v_cvt_pk_bf16_f32 v36, v128, v129
    v_cvt_pk_bf16_f32 v37, v130, v131
    v_cvt_pk_bf16_f32 v38, v132, v133
    v_cvt_pk_bf16_f32 v39, v134, v135
    v_cvt_pk_bf16_f32 v40, v136, v137
    v_cvt_pk_bf16_f32 v41, v138, v139
    v_cvt_pk_bf16_f32 v42, v140, v141
    v_cvt_pk_bf16_f32 v43, v142, v143
    v_mfma_f32_32x32x16_bf16 v[144:159], v[120:123], v[36:39], 0
    s_nop 0
    v_mfma_f32_32x32x16_bf16 v[160:175], v[124:127], v[40:43], 0
    v_bfe_u32 v3, v0, 2, 2
    v_lshl_add_u32 v60, v2, 2, v3
    v_lshlrev_b32 v12, 7, v60
    v_lshrrev_b32 v3, 1, v3
    v_lshl_add_u32 v12, v3, 6, v12
    v_bfe_u32 v3, v0, 4, 1
    v_lshl_add_u32 v12, v3, 5, v12
    v_and_b32 v3, 3, v0
    v_lshl_add_u32 v12, v3, 3, v12
    s_lshl_b32 s70, s66, 14
    v_add_u32 v12, s70, v12
    s_lshl_b32 s70, s68, 6
    v_xor_b32 v12, s70, v12
    v_xor_b32 v13, 64, v12
    v_lshlrev_b32 v14, 10, v1
    v_lshl_add_u32 v14, v2, 3, v14
    v_max3_f32 v184, v144, v145, v146
    v_max3_f32 v185, v152, v153, v154
    v_max3_f32 v184, v184, v147, v148
    v_max3_f32 v185, v185, v155, v156
    v_max3_f32 v184, v184, v149, v150
    v_max3_f32 v185, v185, v157, v158
    v_max_f32 v184, v184, v151
    v_max_f32 v185, v185, v159
    s_nop 1
    v_permlane32_swap_b32 v184, v185
    v_max_f32 v184, v184, v185
    v_mov_b32 v185, v184
    s_nop 1
    v_permlane32_swap_b32 v184, v185
    v_pk_add_f32 v[144:145], v[144:145], v[184:185] op_sel_hi:[1,0] neg_lo:[0,1] neg_hi:[0,1]
    v_pk_add_f32 v[146:147], v[146:147], v[184:185] op_sel_hi:[1,0] neg_lo:[0,1] neg_hi:[0,1]
    v_pk_add_f32 v[148:149], v[148:149], v[184:185] op_sel_hi:[1,0] neg_lo:[0,1] neg_hi:[0,1]
    v_pk_add_f32 v[150:151], v[150:151], v[184:185] op_sel_hi:[1,0] neg_lo:[0,1] neg_hi:[0,1]
    v_pk_add_f32 v[152:153], v[152:153], v[184:185] op_sel:[0,1] op_sel_hi:[1,1] neg_lo:[0,1] neg_hi:[0,1]
    v_pk_add_f32 v[154:155], v[154:155], v[184:185] op_sel:[0,1] op_sel_hi:[1,1] neg_lo:[0,1] neg_hi:[0,1]
    v_pk_add_f32 v[156:157], v[156:157], v[184:185] op_sel:[0,1] op_sel_hi:[1,1] neg_lo:[0,1] neg_hi:[0,1]
    v_pk_add_f32 v[158:159], v[158:159], v[184:185] op_sel:[0,1] op_sel_hi:[1,1] neg_lo:[0,1] neg_hi:[0,1]
    v_exp_f32 v144, v144
    v_exp_f32 v145, v145
    v_exp_f32 v146, v146
    v_exp_f32 v147, v147
    v_exp_f32 v148, v148
    v_exp_f32 v149, v149
    v_exp_f32 v150, v150
    v_exp_f32 v151, v151
    v_exp_f32 v152, v152
    v_exp_f32 v153, v153
    v_exp_f32 v154, v154
    v_exp_f32 v155, v155
    v_exp_f32 v156, v156
    v_exp_f32 v157, v157
    v_exp_f32 v158, v158
    v_exp_f32 v159, v159
    v_pk_add_f32 v[186:187], v[144:145], v[146:147]
    v_pk_add_f32 v[188:189], v[148:149], v[150:151]
    v_pk_add_f32 v[186:187], v[186:187], v[188:189]
    v_add_f32 v184, v186, v187
    v_pk_add_f32 v[186:187], v[152:153], v[154:155]
    v_pk_add_f32 v[188:189], v[156:157], v[158:159]
    v_pk_add_f32 v[186:187], v[186:187], v[188:189]
    v_add_f32 v185, v186, v187
    s_nop 1
    v_permlane32_swap_b32 v184, v185
    v_add_f32 v184, v184, v185
    v_mov_b32 v185, v184
    s_nop 1
    v_permlane32_swap_b32 v184, v185
    v_rcp_f32 v184, v184
    v_rcp_f32 v185, v185
    s_nop 0
    v_pk_mul_f32 v[144:145], v[144:145], v[184:185] op_sel_hi:[1,0]
    v_pk_mul_f32 v[146:147], v[146:147], v[184:185] op_sel_hi:[1,0]
    v_pk_mul_f32 v[148:149], v[148:149], v[184:185] op_sel_hi:[1,0]
    v_pk_mul_f32 v[150:151], v[150:151], v[184:185] op_sel_hi:[1,0]
    v_pk_mul_f32 v[152:153], v[152:153], v[184:185] op_sel:[0,1] op_sel_hi:[1,1]
    v_pk_mul_f32 v[154:155], v[154:155], v[184:185] op_sel:[0,1] op_sel_hi:[1,1]
    v_pk_mul_f32 v[156:157], v[156:157], v[184:185] op_sel:[0,1] op_sel_hi:[1,1]
    v_pk_mul_f32 v[158:159], v[158:159], v[184:185] op_sel:[0,1] op_sel_hi:[1,1]
    v_cvt_pk_bf16_f32 v192, v144, v145
    v_cvt_pk_bf16_f32 v193, v146, v147
    v_cvt_pk_bf16_f32 v194, v148, v149
    v_cvt_pk_bf16_f32 v195, v150, v151
    v_cvt_pk_bf16_f32 v196, v152, v153
    v_cvt_pk_bf16_f32 v197, v154, v155
    v_cvt_pk_bf16_f32 v198, v156, v157
    v_cvt_pk_bf16_f32 v199, v158, v159
    s_lshl_b32 s70, s62, 16
    s_lshl_b32 s71, s67, 15
    s_add_u32 s70, s70, s71
    s_lshl_b32 s71, s63, 7
    s_add_u32 s70, s70, s71
    s_lshl_b32 s71, s68, 6
    s_add_u32 s70, s70, s71
    v_mov_b32 v16, v232
    v_mov_b32 v17, v233
    v_mov_b32 v18, v234
    v_mov_b32 v19, v235
    v_mov_b32 v20, v236
    v_mov_b32 v21, v237
    v_mov_b32 v22, v238
    v_mov_b32 v23, v239
    v_max3_f32 v184, v160, v161, v162
    v_max3_f32 v185, v168, v169, v170
    v_max3_f32 v184, v184, v163, v164
    v_max3_f32 v185, v185, v171, v172
    v_max3_f32 v184, v184, v165, v166
    v_max3_f32 v185, v185, v173, v174
    v_max_f32 v184, v184, v167
    v_max_f32 v185, v185, v175
    s_nop 1
    v_permlane32_swap_b32 v184, v185
    v_max_f32 v184, v184, v185
    v_mov_b32 v185, v184
    s_nop 1
    v_permlane32_swap_b32 v184, v185
    v_pk_add_f32 v[160:161], v[160:161], v[184:185] op_sel_hi:[1,0] neg_lo:[0,1] neg_hi:[0,1]
    v_pk_add_f32 v[162:163], v[162:163], v[184:185] op_sel_hi:[1,0] neg_lo:[0,1] neg_hi:[0,1]
    v_pk_add_f32 v[164:165], v[164:165], v[184:185] op_sel_hi:[1,0] neg_lo:[0,1] neg_hi:[0,1]
    v_pk_add_f32 v[166:167], v[166:167], v[184:185] op_sel_hi:[1,0] neg_lo:[0,1] neg_hi:[0,1]
    v_pk_add_f32 v[168:169], v[168:169], v[184:185] op_sel:[0,1] op_sel_hi:[1,1] neg_lo:[0,1] neg_hi:[0,1]
    v_pk_add_f32 v[170:171], v[170:171], v[184:185] op_sel:[0,1] op_sel_hi:[1,1] neg_lo:[0,1] neg_hi:[0,1]
    v_pk_add_f32 v[172:173], v[172:173], v[184:185] op_sel:[0,1] op_sel_hi:[1,1] neg_lo:[0,1] neg_hi:[0,1]
    v_pk_add_f32 v[174:175], v[174:175], v[184:185] op_sel:[0,1] op_sel_hi:[1,1] neg_lo:[0,1] neg_hi:[0,1]
    v_exp_f32 v160, v160
    v_exp_f32 v161, v161
    v_exp_f32 v162, v162
    v_exp_f32 v163, v163
    v_exp_f32 v164, v164
    v_exp_f32 v165, v165
    v_exp_f32 v166, v166
    v_exp_f32 v167, v167
    v_exp_f32 v168, v168
    v_exp_f32 v169, v169
    v_exp_f32 v170, v170
    v_exp_f32 v171, v171
    v_exp_f32 v172, v172
    v_exp_f32 v173, v173
    v_exp_f32 v174, v174
    v_exp_f32 v175, v175
    v_pk_add_f32 v[186:187], v[160:161], v[162:163]
    v_pk_add_f32 v[188:189], v[164:165], v[166:167]
    v_pk_add_f32 v[186:187], v[186:187], v[188:189]
    v_add_f32 v184, v186, v187
    v_pk_add_f32 v[186:187], v[168:169], v[170:171]
    v_pk_add_f32 v[188:189], v[172:173], v[174:175]
    v_pk_add_f32 v[186:187], v[186:187], v[188:189]
    v_add_f32 v185, v186, v187
    s_nop 1
    v_permlane32_swap_b32 v184, v185
    v_add_f32 v184, v184, v185
    v_mov_b32 v185, v184
    s_nop 1
    v_permlane32_swap_b32 v184, v185
    v_rcp_f32 v184, v184
    v_rcp_f32 v185, v185
    s_nop 0
    v_pk_mul_f32 v[160:161], v[160:161], v[184:185] op_sel_hi:[1,0]
    v_pk_mul_f32 v[162:163], v[162:163], v[184:185] op_sel_hi:[1,0]
    v_pk_mul_f32 v[164:165], v[164:165], v[184:185] op_sel_hi:[1,0]
    v_pk_mul_f32 v[166:167], v[166:167], v[184:185] op_sel_hi:[1,0]
    v_pk_mul_f32 v[168:169], v[168:169], v[184:185] op_sel:[0,1] op_sel_hi:[1,1]
    v_pk_mul_f32 v[170:171], v[170:171], v[184:185] op_sel:[0,1] op_sel_hi:[1,1]
    v_pk_mul_f32 v[172:173], v[172:173], v[184:185] op_sel:[0,1] op_sel_hi:[1,1]
    v_pk_mul_f32 v[174:175], v[174:175], v[184:185] op_sel:[0,1] op_sel_hi:[1,1]
    v_cvt_pk_bf16_f32 v200, v160, v161
    v_cvt_pk_bf16_f32 v201, v162, v163
    v_cvt_pk_bf16_f32 v202, v164, v165
    v_cvt_pk_bf16_f32 v203, v166, v167
    v_cvt_pk_bf16_f32 v204, v168, v169
    v_cvt_pk_bf16_f32 v205, v170, v171
    v_cvt_pk_bf16_f32 v206, v172, v173
    v_cvt_pk_bf16_f32 v207, v174, v175
    s_mov_b32 s24, s48
    s_mov_b32 s25, s49
    s_mov_b32 s26, 2752
    s_mov_b32 s27, 0x20000
    v_lshlrev_b32 v3, 1, v1
    s_mul_i32 s70, s65, 192
    buffer_load_ushort v5, v3, s[24:27], s70 offen offset:0
    buffer_load_ushort v6, v3, s[24:27], s70 offen offset:64
    buffer_load_ushort v7, v3, s[24:27], s70 offen offset:128
    s_lshl_b32 s76, s21, 2
    s_lshl_b32 s70, s68, 1
    s_add_u32 s76, s76, s70
    s_mul_i32 s75, s76, 2304
    s_add_u32 s75, s75, 13631488
    v_lshlrev_b32 v3, 4, v1
    v_lshl_add_u32 v3, v2, 8, v3
    v_lshlrev_b32 v60, 4, v2
    v_add_u32 v60, 2048, v60
    v_cmp_gt_u32 vcc, 16, v1
    v_add_u32 v61, 0, v3
    v_add_u32 v62, 0, v60
    v_cndmask_b32 v8, v62, v61, vcc
    v_add_u32 v61, 512, v3
    v_add_u32 v62, 32, v60
    v_cndmask_b32 v9, v62, v61, vcc
    v_add_u32 v61, 1024, v3
    v_add_u32 v62, 64, v60
    v_cndmask_b32 v10, v62, v61, vcc
    v_add_u32 v61, 1536, v3
    v_add_u32 v62, 96, v60
    v_cndmask_b32 v11, v62, v61, vcc
    ds_read_b32 v62, v110 offset:20
    s_waitcnt lgkmcnt(0)
    v_readfirstlane_b32 s4, v62
    s_mov_b64 exec, 3
    ds_add_u32 v110, v111 offset:28
    s_mov_b64 exec, -1
    v_and_b32 v60, 15, v0
    v_mul_u32_u24 v60, 3072, v60
    v_add_u32 v60, 2060, v60
    s_mul_i32 s71, s76, 24576
    s_add_u32 s71, s71, 14680064
    s_lshl_b32 s70, s23, 7
    s_and_b32 s70, s70, 896
    s_add_u32 s71, s71, s70
    s_mov_b64 exec, 0xffff
    s_mov_b64 s[78:79], 0xffff
PL21:
    buffer_load_dword v61, v60, s[16:19], s71 offen sc1
    s_sub_u32 s5, s5, 1
    s_cmp_lt_i32 s5, 0
    s_cbranch_scc1 PE22
    s_waitcnt vmcnt(0)
    v_cmp_ne_u32 vcc, s69, v61
    s_nop 0
    s_and_b64 vcc, vcc, s[78:79]
    s_cbranch_scc0 PE22
    s_sleep 2
    s_branch PL21
PE22:
    s_mov_b64 exec, -1
    buffer_load_dwordx4 v[160:163], v8, s[16:19], s75 offen sc1
    buffer_load_dwordx4 v[164:167], v9, s[16:19], s75 offen sc1
    buffer_load_dwordx4 v[168:171], v10, s[16:19], s75 offen sc1
    buffer_load_dwordx4 v[172:175], v11, s[16:19], s75 offen sc1
    s_add_u32 s75, s75, 2304
    buffer_load_dwordx4 v[176:179], v8, s[16:19], s75 offen sc1
    buffer_load_dwordx4 v[180:183], v9, s[16:19], s75 offen sc1
    buffer_load_dwordx4 v[184:187], v10, s[16:19], s75 offen sc1
    buffer_load_dwordx4 v[188:191], v11, s[16:19], s75 offen sc1
    s_mov_b32 s34, 0x358637bd
    s_lshl_b32 s70, s62, 4
    s_lshr_b32 s74, s76, 1
    s_add_u32 s70, s70, s74
    s_mul_i32 s70, s70, 6144
    s_lshl_b32 s74, s67, 11
    s_add_u32 s74, s74, s70
    s_add_u32 s74, s74, 6291456
    s_waitcnt vmcnt(4)
    v_cvt_pk_bf16_f32 v88, v160, v161
    v_cvt_pk_bf16_f32 v89, v162, v163
    v_cvt_pk_bf16_f32 v90, v164, v165
    v_cvt_pk_bf16_f32 v91, v166, v167
    v_cvt_pk_bf16_f32 v92, v168, v169
    v_cvt_pk_bf16_f32 v93, v170, v171
    v_cvt_pk_bf16_f32 v94, v172, v173
    v_cvt_pk_bf16_f32 v95, v174, v175
    v_mfma_f32_32x32x16_bf16 v[128:143], v[88:91], v[192:195], 0
    s_nop 0
    v_mfma_f32_32x32x16_bf16 v[128:143], v[92:95], v[196:199], v[128:143]
    s_waitcnt vmcnt(0)
    v_cvt_pk_bf16_f32 v96, v176, v177
    v_cvt_pk_bf16_f32 v97, v178, v179
    v_cvt_pk_bf16_f32 v98, v180, v181
    v_cvt_pk_bf16_f32 v99, v182, v183
    v_cvt_pk_bf16_f32 v100, v184, v185
    v_cvt_pk_bf16_f32 v101, v186, v187
    v_cvt_pk_bf16_f32 v102, v188, v189
    v_cvt_pk_bf16_f32 v103, v190, v191
    v_mfma_f32_32x32x16_bf16 v[144:159], v[96:99], v[200:203], 0
    s_nop 0
    v_mfma_f32_32x32x16_bf16 v[144:159], v[100:103], v[204:207], v[144:159]
    v_add_f32 v112, s34, v136
    v_rcp_f32 v112, v112
    s_nop 0
    v_pk_mul_f32 v[128:129], v[128:129], v[112:113] op_sel_hi:[1,0]
    v_pk_mul_f32 v[130:131], v[130:131], v[112:113] op_sel_hi:[1,0]
    v_pk_mul_f32 v[132:133], v[132:133], v[112:113] op_sel_hi:[1,0]
    v_pk_mul_f32 v[134:135], v[134:135], v[112:113] op_sel_hi:[1,0]
    v_cvt_pk_bf16_f32 v104, v128, v129
    v_cvt_pk_bf16_f32 v105, v130, v131
    v_cvt_pk_bf16_f32 v106, v132, v133
    v_cvt_pk_bf16_f32 v107, v134, v135
    s_nop 0
    v_add_f32 v112, s34, v152
    v_rcp_f32 v112, v112
    s_nop 0
    v_pk_mul_f32 v[144:145], v[144:145], v[112:113] op_sel_hi:[1,0]
    v_pk_mul_f32 v[146:147], v[146:147], v[112:113] op_sel_hi:[1,0]
    v_pk_mul_f32 v[148:149], v[148:149], v[112:113] op_sel_hi:[1,0]
    v_pk_mul_f32 v[150:151], v[150:151], v[112:113] op_sel_hi:[1,0]
    v_cvt_pk_bf16_f32 v108, v144, v145
    v_cvt_pk_bf16_f32 v109, v146, v147
    v_cvt_pk_bf16_f32 v110, v148, v149
    v_cvt_pk_bf16_f32 v111, v150, v151
    s_cmp_eq_u32 s4, 1
    s_cbranch_scc1 HS23
    buffer_store_dwordx4 v[104:107], v4, s[16:19], s74 offen offset:0 sc1
    buffer_store_dwordx4 v[108:111], v4, s[16:19], s74 offen offset:1024 sc1
    s_branch HE24
HS23:
    buffer_store_dwordx4 v[104:107], v4, s[16:19], s74 offen offset:0
    buffer_store_dwordx4 v[108:111], v4, s[16:19], s74 offen offset:1024
HE24:
    s_lshl_b32 s73, s62, 7
    s_add_u32 s73, s73, 4718592
    s_lshl_b32 s70, s21, 4
    s_lshl_b32 s71, s66, 2
    s_add_u32 s70, s70, s71
    s_lshl_b32 s72, s20, 7
    s_add_u32 s72, s72, s70
    s_add_u32 s72, s72, 4718592
    s_lshl_b32 s70, s66, 5
    s_add_u32 s70, s70, s73
    v_lshl_add_u32 v60, v0, 2, s70
    s_lshl_b32 s70, s2, 4
    s_add_u32 s70, s70, s71
    s_add_u32 s70, s70, 4722688
    v_mov_b32 v61, s70
    v_cmp_gt_u32 vcc, 8, v0
    s_nop 1
    v_cndmask_b32 v60, v61, v60, vcc
    s_lshl_b32 s74, s62, 2
    s_add_u32 s74, s74, s66
    s_mul_i32 s74, s74, 24576
    s_add_u32 s74, s74, 6291456
    s_lshl_b32 s70, s67, 11
    s_add_u32 s75, s74, 2048
    s_sub_u32 s75, s75, s70
    s_add_u32 s74, s74, s70
    s_waitcnt vmcnt(0)
    v_mov_b32 v62, s69
    v_mov_b32 v63, 0
    s_mov_b64 exec, 1
    s_cmp_eq_u32 s4, 1
    s_cbranch_scc1 HS25
    buffer_store_dword v62, v63, s[16:19], s72 offen sc1
    s_branch HE26
HS25:
    buffer_store_dword v62, v63, s[16:19], s72 offen
HE26:
    s_mov_b64 exec, -1
    s_mov_b64 s[78:79], 0x1ff
PL27:
    buffer_load_dword v61, v60, s[16:19], 0 offen sc1
    s_sub_u32 s5, s5, 1
    s_cmp_lt_i32 s5, 0
    s_cbranch_scc1 PE28
    s_waitcnt vmcnt(0)
    v_cmp_ne_u32 vcc, s69, v61
    s_nop 0
    s_and_b64 vcc, vcc, s[78:79]
    s_cbranch_scc1 PL27
PE28:
    s_setprio 1
    s_add_u32 s70, s74, 0
    buffer_load_dwordx4 v[64:67], v4, s[16:19], s70 offen offset:0 sc1
    s_add_u32 s71, s75, 0
    buffer_load_dwordx4 v[68:71], v4, s[16:19], s71 offen offset:0 sc1
    buffer_load_dwordx4 v[72:75], v4, s[16:19], s70 offen offset:1024 sc1
    buffer_load_dwordx4 v[76:79], v4, s[16:19], s71 offen offset:1024 sc1
    s_add_u32 s70, s74, 6144
    buffer_load_dwordx4 v[80:83], v4, s[16:19], s70 offen offset:0 sc1
    s_add_u32 s71, s75, 6144
    buffer_load_dwordx4 v[84:87], v4, s[16:19], s71 offen offset:0 sc1
    buffer_load_dwordx4 v[88:91], v4, s[16:19], s70 offen offset:1024 sc1
    buffer_load_dwordx4 v[92:95], v4, s[16:19], s71 offen offset:1024 sc1
    s_add_u32 s70, s74, 12288
    buffer_load_dwordx4 v[96:99], v4, s[16:19], s70 offen offset:0 sc1
    s_add_u32 s71, s75, 12288
    buffer_load_dwordx4 v[100:103], v4, s[16:19], s71 offen offset:0 sc1
    buffer_load_dwordx4 v[104:107], v4, s[16:19], s70 offen offset:1024 sc1
    buffer_load_dwordx4 v[108:111], v4, s[16:19], s71 offen offset:1024 sc1
    s_add_u32 s70, s74, 18432
    buffer_load_dwordx4 v[112:115], v4, s[16:19], s70 offen offset:0 sc1
    s_add_u32 s71, s75, 18432
    buffer_load_dwordx4 v[116:119], v4, s[16:19], s71 offen offset:0 sc1
    buffer_load_dwordx4 v[120:123], v4, s[16:19], s70 offen offset:1024 sc1
    buffer_load_dwordx4 v[124:127], v4, s[16:19], s71 offen offset:1024 sc1
    ds_read_b64_tr_b16 v[36:37], v12 offset:0
    ds_read_b64_tr_b16 v[38:39], v12 offset:1024
    ds_read_b64_tr_b16 v[40:41], v13 offset:0
    ds_read_b64_tr_b16 v[42:43], v13 offset:1024
    s_lshl_b32 s3, s66, 14
    v_add_u32 v56, s3, v4
    v_xor_b32 v57, 16384, v56
    v_xor_b32 v58, 32768, v56
    v_xor_b32 v59, 49152, v56
    v_lshlrev_b32 v192, 16, v16
    v_and_b32 v193, 0xffff0000, v16
    v_lshlrev_b32 v194, 16, v17
    v_and_b32 v195, 0xffff0000, v17
    v_lshlrev_b32 v196, 16, v18
    v_and_b32 v197, 0xffff0000, v18
    v_lshlrev_b32 v198, 16, v19
    v_and_b32 v199, 0xffff0000, v19
    v_lshlrev_b32 v200, 16, v20
    v_and_b32 v201, 0xffff0000, v20
    v_lshlrev_b32 v202, 16, v21
    v_and_b32 v203, 0xffff0000, v21
    v_lshlrev_b32 v204, 16, v22
    v_and_b32 v205, 0xffff0000, v22
    v_lshlrev_b32 v206, 16, v23
    v_and_b32 v207, 0xffff0000, v23
    ds_read_b64_tr_b16 v[44:45], v12 offset:2048
    ds_read_b64_tr_b16 v[46:47], v12 offset:3072
    ds_read_b64_tr_b16 v[48:49], v13 offset:2048
    ds_read_b64_tr_b16 v[50:51], v13 offset:3072
    s_waitcnt vmcnt(14) lgkmcnt(4)
    v_mfma_f32_32x32x16_bf16 v[208:223], v[36:39], v[68:71], 0
    v_mfma_f32_32x32x16_bf16 v[224:239], v[40:43], v[64:67], 0
    v_mfma_f32_32x32x16_bf16 v[240:255], v[40:43], v[68:71], 0
    v_mfma_f32_32x32x16_bf16 v[192:207], v[36:39], v[64:67], v[192:207]
    ds_read_b64_tr_b16 v[36:37], v12 offset:4096
    ds_read_b64_tr_b16 v[38:39], v12 offset:5120
    ds_read_b64_tr_b16 v[40:41], v13 offset:4096
    ds_read_b64_tr_b16 v[42:43], v13 offset:5120
    s_waitcnt vmcnt(12) lgkmcnt(4)
    v_mfma_f32_32x32x16_bf16 v[208:223], v[44:47], v[76:79], v[208:223]
    v_mfma_f32_32x32x16_bf16 v[224:239], v[48:51], v[72:75], v[224:239]
    v_mfma_f32_32x32x16_bf16 v[240:255], v[48:51], v[76:79], v[240:255]
    v_mfma_f32_32x32x16_bf16 v[192:207], v[44:47], v[72:75], v[192:207]
    ds_read_b64_tr_b16 v[44:45], v12 offset:6144
    ds_read_b64_tr_b16 v[46:47], v12 offset:7168
    ds_read_b64_tr_b16 v[48:49], v13 offset:6144
    ds_read_b64_tr_b16 v[50:51], v13 offset:7168
    s_waitcnt vmcnt(10) lgkmcnt(4)
    v_mfma_f32_32x32x16_bf16 v[208:223], v[36:39], v[84:87], v[208:223]
    v_mfma_f32_32x32x16_bf16 v[224:239], v[40:43], v[80:83], v[224:239]
    v_mfma_f32_32x32x16_bf16 v[240:255], v[40:43], v[84:87], v[240:255]
    v_mfma_f32_32x32x16_bf16 v[192:207], v[36:39], v[80:83], v[192:207]
    ds_read_b64_tr_b16 v[36:37], v12 offset:8192
    ds_read_b64_tr_b16 v[38:39], v12 offset:9216
    ds_read_b64_tr_b16 v[40:41], v13 offset:8192
    ds_read_b64_tr_b16 v[42:43], v13 offset:9216
    s_waitcnt vmcnt(8) lgkmcnt(4)
    v_mfma_f32_32x32x16_bf16 v[208:223], v[44:47], v[92:95], v[208:223]
    v_mfma_f32_32x32x16_bf16 v[224:239], v[48:51], v[88:91], v[224:239]
    v_mfma_f32_32x32x16_bf16 v[240:255], v[48:51], v[92:95], v[240:255]
    v_mfma_f32_32x32x16_bf16 v[192:207], v[44:47], v[88:91], v[192:207]
    ds_read_b64_tr_b16 v[44:45], v12 offset:10240
    ds_read_b64_tr_b16 v[46:47], v12 offset:11264
    ds_read_b64_tr_b16 v[48:49], v13 offset:10240
    ds_read_b64_tr_b16 v[50:51], v13 offset:11264
    s_waitcnt vmcnt(6) lgkmcnt(4)
    v_mfma_f32_32x32x16_bf16 v[208:223], v[36:39], v[100:103], v[208:223]
    v_mfma_f32_32x32x16_bf16 v[224:239], v[40:43], v[96:99], v[224:239]
    v_mfma_f32_32x32x16_bf16 v[240:255], v[40:43], v[100:103], v[240:255]
    v_mfma_f32_32x32x16_bf16 v[192:207], v[36:39], v[96:99], v[192:207]
    ds_read_b64_tr_b16 v[36:37], v12 offset:12288
    ds_read_b64_tr_b16 v[38:39], v12 offset:13312
    ds_read_b64_tr_b16 v[40:41], v13 offset:12288
    ds_read_b64_tr_b16 v[42:43], v13 offset:13312
    s_waitcnt vmcnt(4) lgkmcnt(4)
    v_mfma_f32_32x32x16_bf16 v[208:223], v[44:47], v[108:111], v[208:223]
    v_mfma_f32_32x32x16_bf16 v[224:239], v[48:51], v[104:107], v[224:239]
    v_mfma_f32_32x32x16_bf16 v[240:255], v[48:51], v[108:111], v[240:255]
    v_mfma_f32_32x32x16_bf16 v[192:207], v[44:47], v[104:107], v[192:207]
    ds_read_b64_tr_b16 v[44:45], v12 offset:14336
    ds_read_b64_tr_b16 v[46:47], v12 offset:15360
    ds_read_b64_tr_b16 v[48:49], v13 offset:14336
    ds_read_b64_tr_b16 v[50:51], v13 offset:15360
    s_waitcnt vmcnt(2) lgkmcnt(4)
    v_mfma_f32_32x32x16_bf16 v[208:223], v[36:39], v[116:119], v[208:223]
    v_mfma_f32_32x32x16_bf16 v[224:239], v[40:43], v[112:115], v[224:239]
    v_mfma_f32_32x32x16_bf16 v[240:255], v[40:43], v[116:119], v[240:255]
    v_mfma_f32_32x32x16_bf16 v[192:207], v[36:39], v[112:115], v[192:207]
    s_waitcnt vmcnt(0) lgkmcnt(0)
    v_mfma_f32_32x32x16_bf16 v[208:223], v[44:47], v[124:127], v[208:223]
    v_mfma_f32_32x32x16_bf16 v[224:239], v[48:51], v[120:123], v[224:239]
    v_mfma_f32_32x32x16_bf16 v[240:255], v[48:51], v[124:127], v[240:255]
    v_mfma_f32_32x32x16_bf16 v[192:207], v[44:47], v[120:123], v[192:207]
    s_mov_b32 s12, s50
    s_mov_b32 s13, s51
    s_mov_b32 s14, 1409024
    s_mov_b32 s15, 0x20000
    s_mul_i32 s70, s66, 360448
    s_mul_i32 s71, s61, 6144
    s_add_u32 s70, s70, s71
    v_lshlrev_b32 v60, 7, v0
    s_mov_b64 exec, -1
    s_mov_b32 exec_hi, 0xffff
    buffer_load_dword v61, v60, s[12:15], s70 offen
    s_mov_b64 exec, -1
    ds_write_b128 v56, v[208:211] offset:4096
    ds_write_b128 v56, v[212:215] offset:5120
    ds_write_b128 v56, v[216:219] offset:6144
    ds_write_b128 v56, v[220:223] offset:7168
    ds_write_b128 v56, v[224:227] offset:8192
    ds_write_b128 v56, v[228:231] offset:9216
    ds_write_b128 v56, v[232:235] offset:10240
    ds_write_b128 v56, v[236:239] offset:11264
    ds_write_b128 v56, v[240:243] offset:12288
    ds_write_b128 v56, v[244:247] offset:13312
    ds_write_b128 v56, v[248:251] offset:14336
    ds_write_b128 v56, v[252:255] offset:15360
    s_waitcnt lgkmcnt(0)
    s_barrier
    ds_read_b128 v[112:115], v57 offset:4096
    ds_read_b128 v[116:119], v57 offset:5120
    ds_read_b128 v[120:123], v57 offset:6144
    ds_read_b128 v[124:127], v57 offset:7168
    ds_read_b128 v[128:131], v58 offset:8192
    ds_read_b128 v[132:135], v58 offset:9216
    ds_read_b128 v[136:139], v58 offset:10240
    ds_read_b128 v[140:143], v58 offset:11264
    ds_read_b128 v[144:147], v59 offset:12288
    ds_read_b128 v[148:151], v59 offset:13312
    ds_read_b128 v[152:155], v59 offset:14336
    ds_read_b128 v[156:159], v59 offset:15360
    s_waitcnt lgkmcnt(11)
    v_pk_add_f32 v[192:193], v[192:193], v[112:113]
    v_pk_add_f32 v[194:195], v[194:195], v[114:115]
    s_waitcnt lgkmcnt(10)
    v_pk_add_f32 v[196:197], v[196:197], v[116:117]
    v_pk_add_f32 v[198:199], v[198:199], v[118:119]
    s_waitcnt lgkmcnt(9)
    v_pk_add_f32 v[200:201], v[200:201], v[120:121]
    v_pk_add_f32 v[202:203], v[202:203], v[122:123]
    s_waitcnt lgkmcnt(8)
    v_pk_add_f32 v[204:205], v[204:205], v[124:125]
    v_pk_add_f32 v[206:207], v[206:207], v[126:127]
    s_waitcnt lgkmcnt(7)
    v_pk_add_f32 v[192:193], v[192:193], v[128:129]
    v_pk_add_f32 v[194:195], v[194:195], v[130:131]
    s_waitcnt lgkmcnt(6)
    v_pk_add_f32 v[196:197], v[196:197], v[132:133]
    v_pk_add_f32 v[198:199], v[198:199], v[134:135]
    s_waitcnt lgkmcnt(5)
    v_pk_add_f32 v[200:201], v[200:201], v[136:137]
    v_pk_add_f32 v[202:203], v[202:203], v[138:139]
    s_waitcnt lgkmcnt(4)
    v_pk_add_f32 v[204:205], v[204:205], v[140:141]
    v_pk_add_f32 v[206:207], v[206:207], v[142:143]
    s_waitcnt lgkmcnt(3)
    v_pk_add_f32 v[192:193], v[192:193], v[144:145]
    v_pk_add_f32 v[194:195], v[194:195], v[146:147]
    s_waitcnt lgkmcnt(2)
    v_pk_add_f32 v[196:197], v[196:197], v[148:149]
    v_pk_add_f32 v[198:199], v[198:199], v[150:151]
    s_waitcnt lgkmcnt(1)
    v_pk_add_f32 v[200:201], v[200:201], v[152:153]
    v_pk_add_f32 v[202:203], v[202:203], v[154:155]
    s_waitcnt lgkmcnt(0)
    v_pk_add_f32 v[204:205], v[204:205], v[156:157]
    v_pk_add_f32 v[206:207], v[206:207], v[158:159]
    v_cvt_pk_bf16_f32 v40, v192, v193
    v_cvt_pk_bf16_f32 v41, v194, v195
    v_cvt_pk_bf16_f32 v42, v196, v197
    v_cvt_pk_bf16_f32 v43, v198, v199
    v_cvt_pk_bf16_f32 v44, v200, v201
    v_cvt_pk_bf16_f32 v45, v202, v203
    v_cvt_pk_bf16_f32 v46, v204, v205
    v_cvt_pk_bf16_f32 v47, v206, v207
    s_lshl_b32 s70, s62, 1
    s_add_u32 s70, s70, s67
    s_lshl_b32 s71, s63, 1
    s_add_u32 s71, s71, s68
    s_mul_i32 s7, s70, 32768
    s_lshl_b32 s72, s71, 11
    s_add_u32 s7, s7, s72
    s_add_u32 s7, s7, 17825792
    v_pk_mul_f32 v[38:39], v[192:193], v[192:193]
    v_pk_add_f32 v[36:37], v[192:193], v[194:195]
    v_pk_fma_f32 v[38:39], v[194:195], v[194:195], v[38:39]
    v_pk_fma_f32 v[38:39], v[196:197], v[196:197], v[38:39]
    v_pk_add_f32 v[36:37], v[36:37], v[196:197]
    v_pk_fma_f32 v[38:39], v[198:199], v[198:199], v[38:39]
    v_pk_add_f32 v[36:37], v[36:37], v[198:199]
    v_pk_fma_f32 v[38:39], v[200:201], v[200:201], v[38:39]
    v_pk_add_f32 v[36:37], v[36:37], v[200:201]
    v_pk_fma_f32 v[38:39], v[202:203], v[202:203], v[38:39]
    v_pk_add_f32 v[36:37], v[36:37], v[202:203]
    v_pk_fma_f32 v[38:39], v[204:205], v[204:205], v[38:39]
    v_pk_add_f32 v[36:37], v[36:37], v[204:205]
    v_pk_fma_f32 v[38:39], v[206:207], v[206:207], v[38:39]
    v_pk_add_f32 v[36:37], v[36:37], v[206:207]
    v_add_f32 v36, v36, v37
    v_add_f32 v38, v38, v39
    s_nop 1
    v_permlane32_swap_b32 v36, v38
    v_add_f32 v36, v36, v38
    s_lshl_b32 s72, s70, 12
    s_lshl_b32 s73, s71, 8
    s_add_u32 s72, s72, s73
    s_add_u32 s72, s72, 4849664
    v_lshlrev_b32 v37, 2, v0
    buffer_store_dwordx4 v[40:43], v4, s[16:19], s7 offen sc1
    buffer_store_dwordx4 v[44:47], v4, s[16:19], s7 offen offset:1024 sc1
    buffer_store_dword v36, v37, s[16:19], s72 offen sc1
    s_lshl_b32 s76, s70, 6
    s_lshl_b32 s73, s71, 2
    s_add_u32 s76, s76, s73
    s_add_u32 s76, s76, 4726784
    v_bfe_u32 v3, v0, 2, 2
    v_lshl_add_u32 v3, v2, 2, v3
    v_mul_u32_u24 v8, 192, v3
    v_bfe_u32 v3, v0, 4, 1
    v_lshl_add_u32 v8, v3, 5, v8
    v_and_b32 v3, 3, v0
    v_lshl_add_u32 v8, v3, 3, v8
    v_add_u32 v8, 65536, v8
    v_add_u32 v9, 49152, v8
    s_barrier
    v_lshlrev_b32 v3, 2, v0
    ds_read2st64_b32 v[64:65], v3 offset0:0 offset1:64
    ds_read2st64_b32 v[66:67], v3 offset0:1 offset1:65
    ds_read2st64_b32 v[68:69], v3 offset0:2 offset1:66
    s_mov_b32 s12, s50
    s_mov_b32 s13, s51
    s_mov_b32 s14, 1409024
    s_mov_b32 s15, 0x20000
    s_lshl_b32 s35, s64, 2
    s_add_u32 s35, s35, s66
    s_lshl_b32 s75, s35, 6
    s_add_u32 s75, s75, 4726784
    v_lshlrev_b32 v60, 2, v0
    v_and_b32 v60, 63, v60
    v_lshrrev_b32 v70, 3, v0
    v_and_b32 v71, 7, v0
    v_bfe_u32 v72, v0, 4, 1
    v_lshlrev_b32 v72, 2, v72
    v_xor_b32 v71, v71, v72
    v_lshlrev_b32 v71, 4, v71
    v_mul_u32_u24 v70, 1024, v70
    v_add_u32 v10, v70, v71
    v_add_u32 v11, 7168, v10
    v_cmp_gt_u32 vcc, 32, v0
    s_waitcnt lgkmcnt(0)
    v_add_f32 v52, v64, v65
    v_cndmask_b32 v52, 0, v52, vcc
    v_cndmask_b32 v26, 0, v5, vcc
    v_cvt_pk_bf16_f32 v24, v52, v52
    v_lshlrev_b32 v53, 16, v24
    v_sub_f32 v53, v52, v53
    v_cvt_pk_bf16_f32 v53, v53, 0
    v_lshl_or_b32 v25, v26, 16, v53
    v_mov_b32 v27, 0
    v_add_f32 v52, v66, v67
    v_cndmask_b32 v52, 0, v52, vcc
    v_cndmask_b32 v30, 0, v6, vcc
    v_cvt_pk_bf16_f32 v28, v52, v52
    v_lshlrev_b32 v53, 16, v28
    v_sub_f32 v53, v52, v53
    v_cvt_pk_bf16_f32 v53, v53, 0
    v_lshl_or_b32 v29, v30, 16, v53
    v_mov_b32 v31, 0
    v_add_f32 v52, v68, v69
    v_cndmask_b32 v52, 0, v52, vcc
    v_cndmask_b32 v34, 0, v7, vcc
    v_cvt_pk_bf16_f32 v32, v52, v52
    v_lshlrev_b32 v53, 16, v32
    v_sub_f32 v53, v52, v53
    v_cvt_pk_bf16_f32 v53, v53, 0
    v_lshl_or_b32 v33, v34, 16, v53
    v_mov_b32 v35, 0
    s_barrier
    s_waitcnt vmcnt(0)
    v_mov_b32 v62, s69
    v_mov_b32 v63, 0
    s_mov_b64 exec, 1
    s_cmp_eq_u32 s4, 1
    s_cbranch_scc1 HS29
    buffer_store_dword v62, v63, s[16:19], s76 offen sc1
    s_branch HE30
HS29:
    buffer_store_dword v62, v63, s[16:19], s76 offen
HE30:
    s_mov_b64 exec, -1
    s_mov_b64 s[78:79], 0xffff
PL31:
    buffer_load_dword v61, v60, s[16:19], s75 offen sc1
    s_sub_u32 s5, s5, 1
    s_cmp_lt_i32 s5, 0
    s_cbranch_scc1 PE32
    s_waitcnt vmcnt(0)
    v_cmp_ne_u32 vcc, s69, v61
    s_nop 0
    s_and_b64 vcc, vcc, s[78:79]
    s_cbranch_scc1 PL31
PE32:
    s_mul_i32 s74, s35, 32768
    s_add_u32 s74, s74, 17825792
    s_lshl_b32 s75, s35, 12
    s_add_u32 s75, s75, 4849664
    s_cmp_eq_u32 s65, 15
    s_cselect_b32 s70, 0x40000000, 0
    s_or_b32 s74, s74, s70
    s_mul_i32 s76, s66, 360448
    s_lshl_b32 s70, s63, 7
    s_add_u32 s76, s76, s70
    s_mul_i32 s6, s63, 0
    v_lshlrev_b32 v7, 2, v0
    s_lshl_b32 s70, s65, 15
    s_add_u32 s70, s70, 0
    s_and_b32 s70, s70, 0x7fff
    s_add_u32 s70, s70, s74
    buffer_load_dwordx4 v[128:131], v4, s[16:19], s70 offen offset:0 sc1
    buffer_load_dwordx4 v[132:135], v4, s[16:19], s70 offen offset:1024 sc1
    buffer_load_dwordx4 v[136:139], v4, s[16:19], s70 offen offset:2048 sc1
    buffer_load_dwordx4 v[140:143], v4, s[16:19], s70 offen offset:3072 sc1
    s_lshl_b32 s70, s65, 15
    s_add_u32 s70, s70, 4096
    s_and_b32 s70, s70, 0x7fff
    s_add_u32 s70, s70, s74
    buffer_load_dwordx4 v[144:147], v4, s[16:19], s70 offen offset:0 sc1
    buffer_load_dwordx4 v[148:151], v4, s[16:19], s70 offen offset:1024 sc1
    buffer_load_dwordx4 v[152:155], v4, s[16:19], s70 offen offset:2048 sc1
    buffer_load_dwordx4 v[156:159], v4, s[16:19], s70 offen offset:3072 sc1
    ds_read_b64_tr_b16 v[36:37], v8 offset:0
    ds_read_b64_tr_b16 v[38:39], v8 offset:1536
    ds_read_b64_tr_b16 v[40:41], v8 offset:64
    ds_read_b64_tr_b16 v[42:43], v8 offset:1600
    ds_read_b64_tr_b16 v[44:45], v8 offset:128
    ds_read_b64_tr_b16 v[46:47], v8 offset:1664
    s_waitcnt vmcnt(7) lgkmcnt(4)
    v_mfma_f32_32x32x16_bf16 v[64:79], v[36:39], v[128:131], 0
    ds_read_b64_tr_b16 v[48:49], v8 offset:3072
    ds_read_b64_tr_b16 v[50:51], v8 offset:4608
    s_lshl_b32 s70, s65, 15
    s_add_u32 s70, s70, 8192
    s_and_b32 s70, s70, 0x7fff
    s_add_u32 s70, s70, s74
    buffer_load_dwordx4 v[160:163], v4, s[16:19], s70 offen offset:0 sc1
    s_waitcnt lgkmcnt(4)
    v_mfma_f32_32x32x16_bf16 v[80:95], v[40:43], v[128:131], 0
    ds_read_b64_tr_b16 v[52:53], v8 offset:3136
    ds_read_b64_tr_b16 v[54:55], v8 offset:4672
    buffer_load_dwordx4 v[164:167], v4, s[16:19], s70 offen offset:1024 sc1
    s_waitcnt lgkmcnt(4)
    v_mfma_f32_32x32x16_bf16 v[96:111], v[44:47], v[128:131], 0
    ds_read_b64_tr_b16 v[56:57], v8 offset:3200
    ds_read_b64_tr_b16 v[58:59], v8 offset:4736
    buffer_load_dword v112, v7, s[16:19], s75 offen offset:0 sc1
    s_waitcnt vmcnt(9) lgkmcnt(4)
    v_mfma_f32_32x32x16_bf16 v[64:79], v[48:51], v[132:135], v[64:79]
    ds_read_b64_tr_b16 v[36:37], v8 offset:6144
    ds_read_b64_tr_b16 v[38:39], v8 offset:7680
    buffer_load_dword v113, v7, s[16:19], s75 offen offset:256 sc1
    s_waitcnt lgkmcnt(4)
    v_mfma_f32_32x32x16_bf16 v[80:95], v[52:55], v[132:135], v[80:95]
    ds_read_b64_tr_b16 v[40:41], v8 offset:6208
    ds_read_b64_tr_b16 v[42:43], v8 offset:7744
    buffer_load_dword v114, v7, s[16:19], s75 offen offset:512 sc1
    s_waitcnt lgkmcnt(4)
    v_mfma_f32_32x32x16_bf16 v[96:111], v[56:59], v[132:135], v[96:111]
    ds_read_b64_tr_b16 v[44:45], v8 offset:6272
    ds_read_b64_tr_b16 v[46:47], v8 offset:7808
    buffer_load_dword v115, v7, s[16:19], s75 offen offset:768 sc1
    s_waitcnt vmcnt(11) lgkmcnt(4)
    v_mfma_f32_32x32x16_bf16 v[64:79], v[36:39], v[136:139], v[64:79]
    ds_read_b64_tr_b16 v[48:49], v8 offset:9216
    ds_read_b64_tr_b16 v[50:51], v8 offset:10752
    buffer_load_dword v116, v7, s[16:19], s75 offen offset:1024 sc1
    s_waitcnt lgkmcnt(4)
    v_mfma_f32_32x32x16_bf16 v[80:95], v[40:43], v[136:139], v[80:95]
    ds_read_b64_tr_b16 v[52:53], v8 offset:9280
    ds_read_b64_tr_b16 v[54:55], v8 offset:10816
    buffer_load_dword v117, v7, s[16:19], s75 offen offset:1280 sc1
    s_waitcnt lgkmcnt(4)
    v_mfma_f32_32x32x16_bf16 v[96:111], v[44:47], v[136:139], v[96:111]
    ds_read_b64_tr_b16 v[56:57], v8 offset:9344
    ds_read_b64_tr_b16 v[58:59], v8 offset:10880
    buffer_load_dword v118, v7, s[16:19], s75 offen offset:1536 sc1
    s_waitcnt vmcnt(13) lgkmcnt(4)
    v_mfma_f32_32x32x16_bf16 v[64:79], v[48:51], v[140:143], v[64:79]
    ds_read_b64_tr_b16 v[36:37], v8 offset:12288
    ds_read_b64_tr_b16 v[38:39], v8 offset:13824
    buffer_load_dword v119, v7, s[16:19], s75 offen offset:1792 sc1
    s_waitcnt lgkmcnt(4)
    v_mfma_f32_32x32x16_bf16 v[80:95], v[52:55], v[140:143], v[80:95]
    ds_read_b64_tr_b16 v[40:41], v8 offset:12352
    ds_read_b64_tr_b16 v[42:43], v8 offset:13888
    buffer_load_dword v120, v7, s[16:19], s75 offen offset:2048 sc1
    s_waitcnt lgkmcnt(4)
    v_mfma_f32_32x32x16_bf16 v[96:111], v[56:59], v[140:143], v[96:111]
    ds_read_b64_tr_b16 v[44:45], v8 offset:12416
    ds_read_b64_tr_b16 v[46:47], v8 offset:13952
    buffer_load_dword v121, v7, s[16:19], s75 offen offset:2304 sc1
    s_waitcnt vmcnt(15) lgkmcnt(4)
    v_mfma_f32_32x32x16_bf16 v[64:79], v[36:39], v[144:147], v[64:79]
    ds_read_b64_tr_b16 v[48:49], v8 offset:15360
    ds_read_b64_tr_b16 v[50:51], v8 offset:16896
    buffer_load_dword v122, v7, s[16:19], s75 offen offset:2560 sc1
    s_waitcnt lgkmcnt(4)
    v_mfma_f32_32x32x16_bf16 v[80:95], v[40:43], v[144:147], v[80:95]
    ds_read_b64_tr_b16 v[52:53], v8 offset:15424
    ds_read_b64_tr_b16 v[54:55], v8 offset:16960
    buffer_load_dword v123, v7, s[16:19], s75 offen offset:2816 sc1
    s_waitcnt lgkmcnt(4)
    v_mfma_f32_32x32x16_bf16 v[96:111], v[44:47], v[144:147], v[96:111]
    ds_read_b64_tr_b16 v[56:57], v8 offset:15488
    ds_read_b64_tr_b16 v[58:59], v8 offset:17024
    buffer_load_dword v124, v7, s[16:19], s75 offen offset:3072 sc1
    s_waitcnt vmcnt(17) lgkmcnt(4)
    v_mfma_f32_32x32x16_bf16 v[64:79], v[48:51], v[148:151], v[64:79]
    ds_read_b64_tr_b16 v[36:37], v8 offset:18432
    ds_read_b64_tr_b16 v[38:39], v8 offset:19968
    buffer_load_dword v125, v7, s[16:19], s75 offen offset:3328 sc1
    s_waitcnt lgkmcnt(4)
    v_mfma_f32_32x32x16_bf16 v[80:95], v[52:55], v[148:151], v[80:95]
    ds_read_b64_tr_b16 v[40:41], v8 offset:18496
    ds_read_b64_tr_b16 v[42:43], v8 offset:20032
    buffer_load_dword v126, v7, s[16:19], s75 offen offset:3584 sc1
    s_waitcnt lgkmcnt(4)
    v_mfma_f32_32x32x16_bf16 v[96:111], v[56:59], v[148:151], v[96:111]
    ds_read_b64_tr_b16 v[44:45], v8 offset:18560
    ds_read_b64_tr_b16 v[46:47], v8 offset:20096
    buffer_load_dword v127, v7, s[16:19], s75 offen offset:3840 sc1
    s_waitcnt vmcnt(19) lgkmcnt(4)
    v_mfma_f32_32x32x16_bf16 v[64:79], v[36:39], v[152:155], v[64:79]
    ds_read_b64_tr_b16 v[48:49], v8 offset:21504
    ds_read_b64_tr_b16 v[50:51], v8 offset:23040
    buffer_load_dwordx4 v[168:171], v4, s[16:19], s70 offen offset:2048 sc1
    s_waitcnt lgkmcnt(4)
    v_mfma_f32_32x32x16_bf16 v[80:95], v[40:43], v[152:155], v[80:95]
    ds_read_b64_tr_b16 v[52:53], v8 offset:21568
    ds_read_b64_tr_b16 v[54:55], v8 offset:23104
    buffer_load_dwordx4 v[172:175], v4, s[16:19], s70 offen offset:3072 sc1
    s_waitcnt lgkmcnt(4)
    v_mfma_f32_32x32x16_bf16 v[96:111], v[44:47], v[152:155], v[96:111]
    ds_read_b64_tr_b16 v[56:57], v8 offset:21632
    ds_read_b64_tr_b16 v[58:59], v8 offset:23168
    s_lshl_b32 s70, s65, 15
    s_add_u32 s70, s70, 12288
    s_and_b32 s70, s70, 0x7fff
    s_add_u32 s70, s70, s74
    buffer_load_dwordx4 v[176:179], v4, s[16:19], s70 offen offset:0 sc1
    s_waitcnt vmcnt(21) lgkmcnt(4)
    v_mfma_f32_32x32x16_bf16 v[64:79], v[48:51], v[156:159], v[64:79]
    ds_read_b64_tr_b16 v[36:37], v8 offset:24576
    ds_read_b64_tr_b16 v[38:39], v8 offset:26112
    buffer_load_dwordx4 v[180:183], v4, s[16:19], s70 offen offset:1024 sc1
    s_waitcnt lgkmcnt(4)
    v_mfma_f32_32x32x16_bf16 v[80:95], v[52:55], v[156:159], v[80:95]
    ds_read_b64_tr_b16 v[40:41], v8 offset:24640
    ds_read_b64_tr_b16 v[42:43], v8 offset:26176
    buffer_load_dwordx4 v[184:187], v4, s[16:19], s70 offen offset:2048 sc1
    s_waitcnt lgkmcnt(4)
    v_mfma_f32_32x32x16_bf16 v[96:111], v[56:59], v[156:159], v[96:111]
    ds_read_b64_tr_b16 v[44:45], v8 offset:24704
    ds_read_b64_tr_b16 v[46:47], v8 offset:26240
    buffer_load_dwordx4 v[188:191], v4, s[16:19], s70 offen offset:3072 sc1
    s_waitcnt vmcnt(23) lgkmcnt(4)
    v_mfma_f32_32x32x16_bf16 v[64:79], v[36:39], v[160:163], v[64:79]
    ds_read_b64_tr_b16 v[48:49], v8 offset:27648
    ds_read_b64_tr_b16 v[50:51], v8 offset:29184
    s_lshl_b32 s70, s65, 15
    s_add_u32 s70, s70, 16384
    s_and_b32 s70, s70, 0x7fff
    s_add_u32 s70, s70, s74
    buffer_load_dwordx4 v[192:195], v4, s[16:19], s70 offen offset:0 sc1
    s_waitcnt lgkmcnt(4)
    v_mfma_f32_32x32x16_bf16 v[80:95], v[40:43], v[160:163], v[80:95]
    ds_read_b64_tr_b16 v[52:53], v8 offset:27712
    ds_read_b64_tr_b16 v[54:55], v8 offset:29248
    buffer_load_dwordx4 v[196:199], v4, s[16:19], s70 offen offset:1024 sc1
    s_waitcnt lgkmcnt(4)
    v_mfma_f32_32x32x16_bf16 v[96:111], v[44:47], v[160:163], v[96:111]
    ds_read_b64_tr_b16 v[56:57], v8 offset:27776
    ds_read_b64_tr_b16 v[58:59], v8 offset:29312
    buffer_load_dwordx4 v[200:203], v4, s[16:19], s70 offen offset:2048 sc1
    s_waitcnt vmcnt(25) lgkmcnt(4)
    v_mfma_f32_32x32x16_bf16 v[64:79], v[48:51], v[164:167], v[64:79]
    ds_read_b64_tr_b16 v[36:37], v8 offset:30720
    ds_read_b64_tr_b16 v[38:39], v8 offset:32256
    buffer_load_dwordx4 v[204:207], v4, s[16:19], s70 offen offset:3072 sc1
    s_waitcnt lgkmcnt(4)
    v_mfma_f32_32x32x16_bf16 v[80:95], v[52:55], v[164:167], v[80:95]
    ds_read_b64_tr_b16 v[40:41], v8 offset:30784
    ds_read_b64_tr_b16 v[42:43], v8 offset:32320
    s_lshl_b32 s70, s65, 15
    s_add_u32 s70, s70, 20480
    s_and_b32 s70, s70, 0x7fff
    s_add_u32 s70, s70, s74
    buffer_load_dwordx4 v[208:211], v4, s[16:19], s70 offen offset:0 sc1
    s_waitcnt lgkmcnt(4)
    v_mfma_f32_32x32x16_bf16 v[96:111], v[56:59], v[164:167], v[96:111]
    ds_read_b64_tr_b16 v[44:45], v8 offset:30848
    ds_read_b64_tr_b16 v[46:47], v8 offset:32384
    s_waitcnt vmcnt(10) lgkmcnt(4)
    v_mfma_f32_32x32x16_bf16 v[64:79], v[36:39], v[168:171], v[64:79]
    ds_read_b64_tr_b16 v[48:49], v8 offset:33792
    ds_read_b64_tr_b16 v[50:51], v8 offset:35328
    buffer_load_dwordx4 v[212:215], v4, s[16:19], s70 offen offset:1024 sc1
    v_add_f32 v112, v112, v114
    s_waitcnt lgkmcnt(4)
    v_mfma_f32_32x32x16_bf16 v[80:95], v[40:43], v[168:171], v[80:95]
    ds_read_b64_tr_b16 v[52:53], v8 offset:33856
    ds_read_b64_tr_b16 v[54:55], v8 offset:35392
    buffer_load_dwordx4 v[216:219], v4, s[16:19], s70 offen offset:2048 sc1
    v_add_f32 v113, v113, v115
    s_waitcnt lgkmcnt(4)
    v_mfma_f32_32x32x16_bf16 v[96:111], v[44:47], v[168:171], v[96:111]
    ds_read_b64_tr_b16 v[56:57], v8 offset:33920
    ds_read_b64_tr_b16 v[58:59], v8 offset:35456
    v_add_f32 v112, v112, v116
    v_add_f32 v113, v113, v117
    v_add_f32 v112, v112, v118
    s_waitcnt vmcnt(11) lgkmcnt(4)
    v_mfma_f32_32x32x16_bf16 v[64:79], v[48:51], v[172:175], v[64:79]
    ds_read_b64_tr_b16 v[36:37], v8 offset:36864
    ds_read_b64_tr_b16 v[38:39], v8 offset:38400
    buffer_load_dwordx4 v[220:223], v4, s[16:19], s70 offen offset:3072 sc1
    v_add_f32 v113, v113, v119
    s_waitcnt lgkmcnt(4)
    v_mfma_f32_32x32x16_bf16 v[80:95], v[52:55], v[172:175], v[80:95]
    ds_read_b64_tr_b16 v[40:41], v8 offset:36928
    ds_read_b64_tr_b16 v[42:43], v8 offset:38464
    s_lshl_b32 s70, s65, 15
    s_add_u32 s70, s70, 24576
    s_and_b32 s70, s70, 0x7fff
    s_add_u32 s70, s70, s74
    buffer_load_dwordx4 v[224:227], v4, s[16:19], s70 offen offset:0 sc1
    v_add_f32 v112, v112, v120
    s_waitcnt lgkmcnt(4)
    v_mfma_f32_32x32x16_bf16 v[96:111], v[56:59], v[172:175], v[96:111]
    ds_read_b64_tr_b16 v[44:45], v8 offset:36992
    ds_read_b64_tr_b16 v[46:47], v8 offset:38528
    v_add_f32 v113, v113, v121
    v_add_f32 v112, v112, v122
    v_add_f32 v113, v113, v123
    s_waitcnt vmcnt(12) lgkmcnt(4)
    v_mfma_f32_32x32x16_bf16 v[64:79], v[36:39], v[176:179], v[64:79]
    ds_read_b64_tr_b16 v[48:49], v8 offset:39936
    ds_read_b64_tr_b16 v[50:51], v8 offset:41472
    buffer_load_dwordx4 v[228:231], v4, s[16:19], s70 offen offset:1024 sc1
    v_add_f32 v112, v112, v124
    s_waitcnt lgkmcnt(4)
    v_mfma_f32_32x32x16_bf16 v[80:95], v[40:43], v[176:179], v[80:95]
    ds_read_b64_tr_b16 v[52:53], v8 offset:40000
    ds_read_b64_tr_b16 v[54:55], v8 offset:41536
    buffer_load_dwordx4 v[232:235], v4, s[16:19], s70 offen offset:2048 sc1
    v_add_f32 v113, v113, v125
    s_waitcnt lgkmcnt(4)
    v_mfma_f32_32x32x16_bf16 v[96:111], v[44:47], v[176:179], v[96:111]
    ds_read_b64_tr_b16 v[56:57], v8 offset:40064
    ds_read_b64_tr_b16 v[58:59], v8 offset:41600
    v_add_f32 v112, v112, v126
    v_add_f32 v113, v113, v127
    v_add_f32 v112, v112, v113
    s_waitcnt vmcnt(13) lgkmcnt(4)
    v_mfma_f32_32x32x16_bf16 v[64:79], v[48:51], v[180:183], v[64:79]
    ds_read_b64_tr_b16 v[36:37], v8 offset:43008
    ds_read_b64_tr_b16 v[38:39], v8 offset:44544
    buffer_load_dwordx4 v[236:239], v4, s[16:19], s70 offen offset:3072 sc1
    v_mov_b32 v113, v112
    s_waitcnt lgkmcnt(4)
    v_mfma_f32_32x32x16_bf16 v[80:95], v[52:55], v[180:183], v[80:95]
    ds_read_b64_tr_b16 v[40:41], v8 offset:43072
    ds_read_b64_tr_b16 v[42:43], v8 offset:44608
    s_lshl_b32 s70, s65, 15
    s_add_u32 s70, s70, 28672
    s_and_b32 s70, s70, 0x7fff
    s_add_u32 s70, s70, s74
    buffer_load_dwordx4 v[240:243], v4, s[16:19], s70 offen offset:0 sc1
    v_permlane32_swap_b32 v112, v113
    s_waitcnt lgkmcnt(4)
    v_mfma_f32_32x32x16_bf16 v[96:111], v[56:59], v[180:183], v[96:111]
    ds_read_b64_tr_b16 v[44:45], v8 offset:43136
    ds_read_b64_tr_b16 v[46:47], v8 offset:44672
    v_mul_f32 v18, s32, v112
    v_mul_f32 v16, v18, v18
    v_fma_f32 v16, v113, s32, -v16
    s_waitcnt vmcnt(14) lgkmcnt(4)
    v_mfma_f32_32x32x16_bf16 v[64:79], v[36:39], v[184:187], v[64:79]
    ds_read_b64_tr_b16 v[48:49], v8 offset:46080
    ds_read_b64_tr_b16 v[50:51], v8 offset:47616
    buffer_load_dwordx4 v[244:247], v4, s[16:19], s70 offen offset:1024 sc1
    v_max_f32 v16, 0, v16
    s_waitcnt lgkmcnt(4)
    v_mfma_f32_32x32x16_bf16 v[80:95], v[40:43], v[184:187], v[80:95]
    ds_read_b64_tr_b16 v[52:53], v8 offset:46144
    ds_read_b64_tr_b16 v[54:55], v8 offset:47680
    buffer_load_dwordx4 v[248:251], v4, s[16:19], s70 offen offset:2048 sc1
    v_add_f32 v16, s33, v16
    s_waitcnt lgkmcnt(4)
    v_mfma_f32_32x32x16_bf16 v[96:111], v[44:47], v[184:187], v[96:111]
    ds_read_b64_tr_b16 v[56:57], v8 offset:46208
    ds_read_b64_tr_b16 v[58:59], v8 offset:47744
    v_rsq_f32 v19, v16
    v_sub_f32 v18, 0, v18
    v_mul_f32 v16, v16, v19
    s_waitcnt vmcnt(15) lgkmcnt(4)
    v_mfma_f32_32x32x16_bf16 v[64:79], v[48:51], v[188:191], v[64:79]
    ds_read_b64_tr_b16 v[36:37], v9 offset:0
    ds_read_b64_tr_b16 v[38:39], v9 offset:1536
    buffer_load_dwordx4 v[252:255], v4, s[16:19], s70 offen offset:3072 sc1
    v_cvt_pk_bf16_f32 v21, v18, v16
    s_waitcnt lgkmcnt(4)
    v_mfma_f32_32x32x16_bf16 v[80:95], v[52:55], v[188:191], v[80:95]
    ds_read_b64_tr_b16 v[40:41], v9 offset:64
    ds_read_b64_tr_b16 v[42:43], v9 offset:1600
    v_lshlrev_b32 v60, 16, v21
    v_sub_f32 v60, v18, v60
    v_cvt_pk_bf16_f32 v20, v18, v60
    s_waitcnt lgkmcnt(4)
    v_mfma_f32_32x32x16_bf16 v[96:111], v[56:59], v[188:191], v[96:111]
    ds_read_b64_tr_b16 v[44:45], v9 offset:128
    ds_read_b64_tr_b16 v[46:47], v9 offset:1664
    v_and_b32 v60, 0xffff0000, v21
    v_sub_f32 v60, v16, v60
    v_cvt_pk_bf16_f32 v22, v60, 0
    s_barrier
    s_waitcnt vmcnt(15) lgkmcnt(4)
    v_mfma_f32_32x32x16_bf16 v[64:79], v[36:39], v[192:195], v[64:79]
    ds_read_b64_tr_b16 v[48:49], v9 offset:3072
    ds_read_b64_tr_b16 v[50:51], v9 offset:4608
    v_mov_b32 v23, 0
    v_mul_f32 v15, 0xc0135761, v19
    v_mul_f32 v60, v19, v19
    s_waitcnt lgkmcnt(4)
    v_mfma_f32_32x32x16_bf16 v[80:95], v[40:43], v[192:195], v[80:95]
    ds_read_b64_tr_b16 v[52:53], v9 offset:3136
    ds_read_b64_tr_b16 v[54:55], v9 offset:4672
    v_mul_f32 v60, v60, v19
    v_mul_f32 v14, 0xbdd2d3e8, v60
    s_waitcnt lgkmcnt(4)
    v_mfma_f32_32x32x16_bf16 v[96:111], v[44:47], v[192:195], v[96:111]
    ds_read_b64_tr_b16 v[56:57], v9 offset:3200
    ds_read_b64_tr_b16 v[58:59], v9 offset:4736
    v_mfma_f32_32x32x16_bf16 v[64:79], v[24:27], v[20:23], v[64:79]
    v_mfma_f32_32x32x16_bf16 v[80:95], v[28:31], v[20:23], v[80:95]
    v_mfma_f32_32x32x16_bf16 v[96:111], v[32:35], v[20:23], v[96:111]
    s_waitcnt vmcnt(14) lgkmcnt(4)
    v_mfma_f32_32x32x16_bf16 v[64:79], v[48:51], v[196:199], v[64:79]
    ds_read_b64_tr_b16 v[36:37], v9 offset:6144
    ds_read_b64_tr_b16 v[38:39], v9 offset:7680
    s_waitcnt lgkmcnt(4)
    v_mfma_f32_32x32x16_bf16 v[80:95], v[52:55], v[196:199], v[80:95]
    ds_read_b64_tr_b16 v[40:41], v9 offset:6208
    ds_read_b64_tr_b16 v[42:43], v9 offset:7744
    s_waitcnt lgkmcnt(4)
    v_mfma_f32_32x32x16_bf16 v[96:111], v[56:59], v[196:199], v[96:111]
    ds_read_b64_tr_b16 v[44:45], v9 offset:6272
    ds_read_b64_tr_b16 v[46:47], v9 offset:7808
    s_waitcnt vmcnt(13) lgkmcnt(4)
    v_mfma_f32_32x32x16_bf16 v[64:79], v[36:39], v[200:203], v[64:79]
    ds_read_b64_tr_b16 v[48:49], v9 offset:9216
    ds_read_b64_tr_b16 v[50:51], v9 offset:10752
    s_waitcnt lgkmcnt(4)
    v_mfma_f32_32x32x16_bf16 v[80:95], v[40:43], v[200:203], v[80:95]
    ds_read_b64_tr_b16 v[52:53], v9 offset:9280
    ds_read_b64_tr_b16 v[54:55], v9 offset:10816
    s_waitcnt lgkmcnt(4)
    v_mfma_f32_32x32x16_bf16 v[96:111], v[44:47], v[200:203], v[96:111]
    ds_read_b64_tr_b16 v[56:57], v9 offset:9344
    ds_read_b64_tr_b16 v[58:59], v9 offset:10880
    s_waitcnt vmcnt(12) lgkmcnt(4)
    v_mfma_f32_32x32x16_bf16 v[64:79], v[48:51], v[204:207], v[64:79]
    ds_read_b64_tr_b16 v[36:37], v9 offset:12288
    ds_read_b64_tr_b16 v[38:39], v9 offset:13824
    s_waitcnt lgkmcnt(4)
    v_mfma_f32_32x32x16_bf16 v[80:95], v[52:55], v[204:207], v[80:95]
    ds_read_b64_tr_b16 v[40:41], v9 offset:12352
    ds_read_b64_tr_b16 v[42:43], v9 offset:13888
    s_waitcnt lgkmcnt(4)
    v_mfma_f32_32x32x16_bf16 v[96:111], v[56:59], v[204:207], v[96:111]
    ds_read_b64_tr_b16 v[44:45], v9 offset:12416
    ds_read_b64_tr_b16 v[46:47], v9 offset:13952
    s_waitcnt vmcnt(11) lgkmcnt(4)
    v_mfma_f32_32x32x16_bf16 v[64:79], v[36:39], v[208:211], v[64:79]
    ds_read_b64_tr_b16 v[48:49], v9 offset:15360
    ds_read_b64_tr_b16 v[50:51], v9 offset:16896
    s_waitcnt lgkmcnt(4)
    v_mfma_f32_32x32x16_bf16 v[80:95], v[40:43], v[208:211], v[80:95]
    ds_read_b64_tr_b16 v[52:53], v9 offset:15424
    ds_read_b64_tr_b16 v[54:55], v9 offset:16960
    s_waitcnt lgkmcnt(4)
    v_mfma_f32_32x32x16_bf16 v[96:111], v[44:47], v[208:211], v[96:111]
    ds_read_b64_tr_b16 v[56:57], v9 offset:15488
    ds_read_b64_tr_b16 v[58:59], v9 offset:17024
    s_waitcnt vmcnt(10) lgkmcnt(4)
    v_mfma_f32_32x32x16_bf16 v[64:79], v[48:51], v[212:215], v[64:79]
    ds_read_b64_tr_b16 v[36:37], v9 offset:18432
    ds_read_b64_tr_b16 v[38:39], v9 offset:19968
    s_waitcnt lgkmcnt(4)
    v_mfma_f32_32x32x16_bf16 v[80:95], v[52:55], v[212:215], v[80:95]
    ds_read_b64_tr_b16 v[40:41], v9 offset:18496
    ds_read_b64_tr_b16 v[42:43], v9 offset:20032
    s_waitcnt lgkmcnt(4)
    v_mfma_f32_32x32x16_bf16 v[96:111], v[56:59], v[212:215], v[96:111]
    ds_read_b64_tr_b16 v[44:45], v9 offset:18560
    ds_read_b64_tr_b16 v[46:47], v9 offset:20096
    s_waitcnt vmcnt(9) lgkmcnt(4)
    v_mfma_f32_32x32x16_bf16 v[64:79], v[36:39], v[216:219], v[64:79]
    ds_read_b64_tr_b16 v[48:49], v9 offset:21504
    ds_read_b64_tr_b16 v[50:51], v9 offset:23040
    s_waitcnt lgkmcnt(4)
    v_mfma_f32_32x32x16_bf16 v[80:95], v[40:43], v[216:219], v[80:95]
    ds_read_b64_tr_b16 v[52:53], v9 offset:21568
    ds_read_b64_tr_b16 v[54:55], v9 offset:23104
    s_waitcnt lgkmcnt(4)
    v_mfma_f32_32x32x16_bf16 v[96:111], v[44:47], v[216:219], v[96:111]
    ds_read_b64_tr_b16 v[56:57], v9 offset:21632
    ds_read_b64_tr_b16 v[58:59], v9 offset:23168
    s_waitcnt vmcnt(8) lgkmcnt(4)
    v_mfma_f32_32x32x16_bf16 v[64:79], v[48:51], v[220:223], v[64:79]
    ds_read_b64_tr_b16 v[36:37], v9 offset:24576
    ds_read_b64_tr_b16 v[38:39], v9 offset:26112
    s_waitcnt lgkmcnt(4)
    v_mfma_f32_32x32x16_bf16 v[80:95], v[52:55], v[220:223], v[80:95]
    ds_read_b64_tr_b16 v[40:41], v9 offset:24640
    ds_read_b64_tr_b16 v[42:43], v9 offset:26176
    s_waitcnt lgkmcnt(4)
    v_mfma_f32_32x32x16_bf16 v[96:111], v[56:59], v[220:223], v[96:111]
    ds_read_b64_tr_b16 v[44:45], v9 offset:24704
    ds_read_b64_tr_b16 v[46:47], v9 offset:26240
    s_waitcnt vmcnt(7) lgkmcnt(4)
    v_mfma_f32_32x32x16_bf16 v[64:79], v[36:39], v[224:227], v[64:79]
    ds_read_b64_tr_b16 v[48:49], v9 offset:27648
    ds_read_b64_tr_b16 v[50:51], v9 offset:29184
    s_waitcnt lgkmcnt(4)
    v_mfma_f32_32x32x16_bf16 v[80:95], v[40:43], v[224:227], v[80:95]
    ds_read_b64_tr_b16 v[52:53], v9 offset:27712
    ds_read_b64_tr_b16 v[54:55], v9 offset:29248
    s_waitcnt lgkmcnt(4)
    v_mfma_f32_32x32x16_bf16 v[96:111], v[44:47], v[224:227], v[96:111]
    ds_read_b64_tr_b16 v[56:57], v9 offset:27776
    ds_read_b64_tr_b16 v[58:59], v9 offset:29312
    s_waitcnt vmcnt(6) lgkmcnt(4)
    v_mfma_f32_32x32x16_bf16 v[64:79], v[48:51], v[228:231], v[64:79]
    ds_read_b64_tr_b16 v[36:37], v9 offset:30720
    ds_read_b64_tr_b16 v[38:39], v9 offset:32256
    s_waitcnt lgkmcnt(4)
    v_mfma_f32_32x32x16_bf16 v[80:95], v[52:55], v[228:231], v[80:95]
    ds_read_b64_tr_b16 v[40:41], v9 offset:30784
    ds_read_b64_tr_b16 v[42:43], v9 offset:32320
    s_waitcnt lgkmcnt(4)
    v_mfma_f32_32x32x16_bf16 v[96:111], v[56:59], v[228:231], v[96:111]
    ds_read_b64_tr_b16 v[44:45], v9 offset:30848
    ds_read_b64_tr_b16 v[46:47], v9 offset:32384
    s_waitcnt vmcnt(5) lgkmcnt(4)
    v_mfma_f32_32x32x16_bf16 v[64:79], v[36:39], v[232:235], v[64:79]
    ds_read_b64_tr_b16 v[48:49], v9 offset:33792
    ds_read_b64_tr_b16 v[50:51], v9 offset:35328
    s_waitcnt lgkmcnt(4)
    v_mfma_f32_32x32x16_bf16 v[80:95], v[40:43], v[232:235], v[80:95]
    ds_read_b64_tr_b16 v[52:53], v9 offset:33856
    ds_read_b64_tr_b16 v[54:55], v9 offset:35392
    s_waitcnt lgkmcnt(4)
    v_mfma_f32_32x32x16_bf16 v[96:111], v[44:47], v[232:235], v[96:111]
    ds_read_b64_tr_b16 v[56:57], v9 offset:33920
    ds_read_b64_tr_b16 v[58:59], v9 offset:35456
    s_waitcnt vmcnt(4) lgkmcnt(4)
    v_mfma_f32_32x32x16_bf16 v[64:79], v[48:51], v[236:239], v[64:79]
    ds_read_b64_tr_b16 v[36:37], v9 offset:36864
    ds_read_b64_tr_b16 v[38:39], v9 offset:38400
    s_waitcnt lgkmcnt(4)
    v_mfma_f32_32x32x16_bf16 v[80:95], v[52:55], v[236:239], v[80:95]
    ds_read_b64_tr_b16 v[40:41], v9 offset:36928
    ds_read_b64_tr_b16 v[42:43], v9 offset:38464
    s_waitcnt lgkmcnt(4)
    v_mfma_f32_32x32x16_bf16 v[96:111], v[56:59], v[236:239], v[96:111]
    ds_read_b64_tr_b16 v[44:45], v9 offset:36992
    ds_read_b64_tr_b16 v[46:47], v9 offset:38528
    s_waitcnt vmcnt(3) lgkmcnt(4)
    v_mfma_f32_32x32x16_bf16 v[64:79], v[36:39], v[240:243], v[64:79]
    ds_read_b64_tr_b16 v[48:49], v9 offset:39936
    ds_read_b64_tr_b16 v[50:51], v9 offset:41472
    s_waitcnt lgkmcnt(4)
    v_mfma_f32_32x32x16_bf16 v[80:95], v[40:43], v[240:243], v[80:95]
    ds_read_b64_tr_b16 v[52:53], v9 offset:40000
    ds_read_b64_tr_b16 v[54:55], v9 offset:41536
    s_waitcnt lgkmcnt(4)
    v_mfma_f32_32x32x16_bf16 v[96:111], v[44:47], v[240:243], v[96:111]
    ds_read_b64_tr_b16 v[56:57], v9 offset:40064
    ds_read_b64_tr_b16 v[58:59], v9 offset:41600
    s_waitcnt vmcnt(2) lgkmcnt(4)
    v_mfma_f32_32x32x16_bf16 v[64:79], v[48:51], v[244:247], v[64:79]
    ds_read_b64_tr_b16 v[36:37], v9 offset:43008
    ds_read_b64_tr_b16 v[38:39], v9 offset:44544
    s_waitcnt lgkmcnt(4)
    v_mfma_f32_32x32x16_bf16 v[80:95], v[52:55], v[244:247], v[80:95]
    ds_read_b64_tr_b16 v[40:41], v9 offset:43072
    ds_read_b64_tr_b16 v[42:43], v9 offset:44608
    s_waitcnt lgkmcnt(4)
    v_mfma_f32_32x32x16_bf16 v[96:111], v[56:59], v[244:247], v[96:111]
    ds_read_b64_tr_b16 v[44:45], v9 offset:43136
    ds_read_b64_tr_b16 v[46:47], v9 offset:44672
    s_waitcnt vmcnt(1) lgkmcnt(4)
    v_mfma_f32_32x32x16_bf16 v[64:79], v[36:39], v[248:251], v[64:79]
    ds_read_b64_tr_b16 v[48:49], v9 offset:46080
    ds_read_b64_tr_b16 v[50:51], v9 offset:47616
    s_waitcnt lgkmcnt(4)
    v_mfma_f32_32x32x16_bf16 v[80:95], v[40:43], v[248:251], v[80:95]
    ds_read_b64_tr_b16 v[52:53], v9 offset:46144
    ds_read_b64_tr_b16 v[54:55], v9 offset:47680
    s_waitcnt lgkmcnt(4)
    v_mfma_f32_32x32x16_bf16 v[96:111], v[44:47], v[248:251], v[96:111]
    ds_read_b64_tr_b16 v[56:57], v9 offset:46208
    ds_read_b64_tr_b16 v[58:59], v9 offset:47744
    s_waitcnt vmcnt(0) lgkmcnt(4)
    v_mfma_f32_32x32x16_bf16 v[64:79], v[48:51], v[252:255], v[64:79]
    s_waitcnt lgkmcnt(2)
    v_mfma_f32_32x32x16_bf16 v[80:95], v[52:55], v[252:255], v[80:95]
    s_waitcnt lgkmcnt(0)
    v_mfma_f32_32x32x16_bf16 v[96:111], v[56:59], v[252:255], v[96:111]
    s_mul_i32 s74, s35, 88064
    s_mul_i32 s71, s65, 6144
    s_add_u32 s74, s74, s71
    s_add_u32 s74, s74, 20971520
    s_barrier
    s_mov_b32 s24, s52
    s_mov_b32 s25, s53
    s_mov_b32 s26, 1024
    s_mov_b32 s27, 0x20000
    v_lshlrev_b32 v61, 3, v2
    s_lshl_b32 s73, s63, 7
    s_lshl_b32 s70, s68, 6
    s_add_u32 s73, s73, s70
    buffer_load_dwordx4 v[208:211], v4, s[16:19], s7 offen offset:0 sc1
    buffer_load_dwordx4 v[212:215], v4, s[16:19], s7 offen offset:1024 sc1
    buffer_load_dwordx2 v[216:217], v61, s[24:27], s73 offen offset:0
    buffer_load_dwordx2 v[218:219], v61, s[24:27], s73 offen offset:16
    buffer_load_dwordx2 v[220:221], v61, s[24:27], s73 offen offset:32
    buffer_load_dwordx2 v[222:223], v61, s[24:27], s73 offen offset:48
    v_pk_mul_f32 v[112:113], v[64:65], v[64:65]
    v_pk_mul_f32 v[114:115], v[66:67], v[66:67]
    v_pk_mul_f32 v[116:117], v[68:69], v[68:69]
    v_pk_mul_f32 v[118:119], v[70:71], v[70:71]
    v_pk_mul_f32 v[120:121], v[72:73], v[72:73]
    v_pk_mul_f32 v[122:123], v[74:75], v[74:75]
    v_pk_mul_f32 v[124:125], v[76:77], v[76:77]
    v_pk_mul_f32 v[126:127], v[78:79], v[78:79]
    v_pk_fma_f32 v[112:113], v[112:113], v[14:15], v[14:15] op_sel:[0,0,1] op_sel_hi:[1,0,1]
    v_pk_fma_f32 v[114:115], v[114:115], v[14:15], v[14:15] op_sel:[0,0,1] op_sel_hi:[1,0,1]
    v_pk_fma_f32 v[116:117], v[116:117], v[14:15], v[14:15] op_sel:[0,0,1] op_sel_hi:[1,0,1]
    v_pk_fma_f32 v[118:119], v[118:119], v[14:15], v[14:15] op_sel:[0,0,1] op_sel_hi:[1,0,1]
    v_pk_fma_f32 v[120:121], v[120:121], v[14:15], v[14:15] op_sel:[0,0,1] op_sel_hi:[1,0,1]
    v_pk_fma_f32 v[122:123], v[122:123], v[14:15], v[14:15] op_sel:[0,0,1] op_sel_hi:[1,0,1]
    v_pk_fma_f32 v[124:125], v[124:125], v[14:15], v[14:15] op_sel:[0,0,1] op_sel_hi:[1,0,1]
    v_pk_fma_f32 v[126:127], v[126:127], v[14:15], v[14:15] op_sel:[0,0,1] op_sel_hi:[1,0,1]
    v_pk_mul_f32 v[112:113], v[112:113], v[64:65]
    v_pk_mul_f32 v[114:115], v[114:115], v[66:67]
    v_pk_mul_f32 v[116:117], v[116:117], v[68:69]
    v_pk_mul_f32 v[118:119], v[118:119], v[70:71]
    v_pk_mul_f32 v[120:121], v[120:121], v[72:73]
    v_pk_mul_f32 v[122:123], v[122:123], v[74:75]
    v_pk_mul_f32 v[124:125], v[124:125], v[76:77]
    v_pk_mul_f32 v[126:127], v[126:127], v[78:79]
    v_exp_f32 v112, v112
    v_exp_f32 v113, v113
    v_exp_f32 v114, v114
    v_exp_f32 v115, v115
    v_exp_f32 v116, v116
    v_exp_f32 v117, v117
    v_exp_f32 v118, v118
    v_exp_f32 v119, v119
    v_exp_f32 v120, v120
    v_exp_f32 v121, v121
    v_exp_f32 v122, v122
    v_exp_f32 v123, v123
    v_exp_f32 v124, v124
    v_exp_f32 v125, v125
    v_exp_f32 v126, v126
    v_exp_f32 v127, v127
    v_pk_fma_f32 v[112:113], v[112:113], v[16:17], v[16:17] op_sel_hi:[1,0,0]
    v_pk_fma_f32 v[114:115], v[114:115], v[16:17], v[16:17] op_sel_hi:[1,0,0]
    v_pk_fma_f32 v[116:117], v[116:117], v[16:17], v[16:17] op_sel_hi:[1,0,0]
    v_pk_fma_f32 v[118:119], v[118:119], v[16:17], v[16:17] op_sel_hi:[1,0,0]
    v_pk_fma_f32 v[120:121], v[120:121], v[16:17], v[16:17] op_sel_hi:[1,0,0]
    v_pk_fma_f32 v[122:123], v[122:123], v[16:17], v[16:17] op_sel_hi:[1,0,0]
    v_pk_fma_f32 v[124:125], v[124:125], v[16:17], v[16:17] op_sel_hi:[1,0,0]
    v_pk_fma_f32 v[126:127], v[126:127], v[16:17], v[16:17] op_sel_hi:[1,0,0]
    v_rcp_f32 v112, v112
    v_rcp_f32 v113, v113
    v_rcp_f32 v114, v114
    v_rcp_f32 v115, v115
    v_rcp_f32 v116, v116
    v_rcp_f32 v117, v117
    v_rcp_f32 v118, v118
    v_rcp_f32 v119, v119
    v_rcp_f32 v120, v120
    v_rcp_f32 v121, v121
    v_rcp_f32 v122, v122
    v_rcp_f32 v123, v123
    v_rcp_f32 v124, v124
    v_rcp_f32 v125, v125
    v_rcp_f32 v126, v126
    v_rcp_f32 v127, v127
    v_pk_mul_f32 v[64:65], v[64:65], v[112:113]
    v_pk_mul_f32 v[66:67], v[66:67], v[114:115]
    v_pk_mul_f32 v[68:69], v[68:69], v[116:117]
    v_pk_mul_f32 v[70:71], v[70:71], v[118:119]
    v_pk_mul_f32 v[72:73], v[72:73], v[120:121]
    v_pk_mul_f32 v[74:75], v[74:75], v[122:123]
    v_pk_mul_f32 v[76:77], v[76:77], v[124:125]
    v_pk_mul_f32 v[78:79], v[78:79], v[126:127]
    v_cvt_pk_bf16_f32 v24, v64, v65
    v_cvt_pk_bf16_f32 v25, v66, v67
    v_cvt_pk_bf16_f32 v26, v68, v69
    v_cvt_pk_bf16_f32 v27, v70, v71
    v_cvt_pk_bf16_f32 v28, v72, v73
    v_cvt_pk_bf16_f32 v29, v74, v75
    v_cvt_pk_bf16_f32 v30, v76, v77
    v_cvt_pk_bf16_f32 v31, v78, v79
    s_cmp_ge_u32 s65, 15
    s_cbranch_scc1 P3_NOST0
    buffer_store_dwordx4 v[24:27], v4, s[16:19], s74 offen offset:0 sc1
    buffer_store_dwordx4 v[28:31], v4, s[16:19], s74 offen offset:1024 sc1
P3_NOST0:
    v_pk_mul_f32 v[112:113], v[80:81], v[80:81]
    v_pk_mul_f32 v[114:115], v[82:83], v[82:83]
    v_pk_mul_f32 v[116:117], v[84:85], v[84:85]
    v_pk_mul_f32 v[118:119], v[86:87], v[86:87]
    v_pk_mul_f32 v[120:121], v[88:89], v[88:89]
    v_pk_mul_f32 v[122:123], v[90:91], v[90:91]
    v_pk_mul_f32 v[124:125], v[92:93], v[92:93]
    v_pk_mul_f32 v[126:127], v[94:95], v[94:95]
    v_pk_fma_f32 v[112:113], v[112:113], v[14:15], v[14:15] op_sel:[0,0,1] op_sel_hi:[1,0,1]
    v_pk_fma_f32 v[114:115], v[114:115], v[14:15], v[14:15] op_sel:[0,0,1] op_sel_hi:[1,0,1]
    v_pk_fma_f32 v[116:117], v[116:117], v[14:15], v[14:15] op_sel:[0,0,1] op_sel_hi:[1,0,1]
    v_pk_fma_f32 v[118:119], v[118:119], v[14:15], v[14:15] op_sel:[0,0,1] op_sel_hi:[1,0,1]
    v_pk_fma_f32 v[120:121], v[120:121], v[14:15], v[14:15] op_sel:[0,0,1] op_sel_hi:[1,0,1]
    v_pk_fma_f32 v[122:123], v[122:123], v[14:15], v[14:15] op_sel:[0,0,1] op_sel_hi:[1,0,1]
    v_pk_fma_f32 v[124:125], v[124:125], v[14:15], v[14:15] op_sel:[0,0,1] op_sel_hi:[1,0,1]
    v_pk_fma_f32 v[126:127], v[126:127], v[14:15], v[14:15] op_sel:[0,0,1] op_sel_hi:[1,0,1]
    v_pk_mul_f32 v[112:113], v[112:113], v[80:81]
    v_pk_mul_f32 v[114:115], v[114:115], v[82:83]
    v_pk_mul_f32 v[116:117], v[116:117], v[84:85]
    v_pk_mul_f32 v[118:119], v[118:119], v[86:87]
    v_pk_mul_f32 v[120:121], v[120:121], v[88:89]
    v_pk_mul_f32 v[122:123], v[122:123], v[90:91]
    v_pk_mul_f32 v[124:125], v[124:125], v[92:93]
    v_pk_mul_f32 v[126:127], v[126:127], v[94:95]
    v_exp_f32 v112, v112
    v_exp_f32 v113, v113
    v_exp_f32 v114, v114
    v_exp_f32 v115, v115
    v_exp_f32 v116, v116
    v_exp_f32 v117, v117
    v_exp_f32 v118, v118
    v_exp_f32 v119, v119
    v_exp_f32 v120, v120
    v_exp_f32 v121, v121
    v_exp_f32 v122, v122
    v_exp_f32 v123, v123
    v_exp_f32 v124, v124
    v_exp_f32 v125, v125
    v_exp_f32 v126, v126
    v_exp_f32 v127, v127
    v_pk_fma_f32 v[112:113], v[112:113], v[16:17], v[16:17] op_sel_hi:[1,0,0]
    v_pk_fma_f32 v[114:115], v[114:115], v[16:17], v[16:17] op_sel_hi:[1,0,0]
    v_pk_fma_f32 v[116:117], v[116:117], v[16:17], v[16:17] op_sel_hi:[1,0,0]
    v_pk_fma_f32 v[118:119], v[118:119], v[16:17], v[16:17] op_sel_hi:[1,0,0]
    v_pk_fma_f32 v[120:121], v[120:121], v[16:17], v[16:17] op_sel_hi:[1,0,0]
    v_pk_fma_f32 v[122:123], v[122:123], v[16:17], v[16:17] op_sel_hi:[1,0,0]
    v_pk_fma_f32 v[124:125], v[124:125], v[16:17], v[16:17] op_sel_hi:[1,0,0]
    v_pk_fma_f32 v[126:127], v[126:127], v[16:17], v[16:17] op_sel_hi:[1,0,0]
    v_rcp_f32 v112, v112
    v_rcp_f32 v113, v113
    v_rcp_f32 v114, v114
    v_rcp_f32 v115, v115
    v_rcp_f32 v116, v116
    v_rcp_f32 v117, v117
    v_rcp_f32 v118, v118
    v_rcp_f32 v119, v119
    v_rcp_f32 v120, v120
    v_rcp_f32 v121, v121
    v_rcp_f32 v122, v122
    v_rcp_f32 v123, v123
    v_rcp_f32 v124, v124
    v_rcp_f32 v125, v125
    v_rcp_f32 v126, v126
    v_rcp_f32 v127, v127
    v_pk_mul_f32 v[80:81], v[80:81], v[112:113]
    v_pk_mul_f32 v[82:83], v[82:83], v[114:115]
    v_pk_mul_f32 v[84:85], v[84:85], v[116:117]
    v_pk_mul_f32 v[86:87], v[86:87], v[118:119]
    v_pk_mul_f32 v[88:89], v[88:89], v[120:121]
    v_pk_mul_f32 v[90:91], v[90:91], v[122:123]
    v_pk_mul_f32 v[92:93], v[92:93], v[124:125]
    v_pk_mul_f32 v[94:95], v[94:95], v[126:127]
    v_cvt_pk_bf16_f32 v32, v80, v81
    v_cvt_pk_bf16_f32 v33, v82, v83
    v_cvt_pk_bf16_f32 v34, v84, v85
    v_cvt_pk_bf16_f32 v35, v86, v87
    v_cvt_pk_bf16_f32 v36, v88, v89
    v_cvt_pk_bf16_f32 v37, v90, v91
    v_cvt_pk_bf16_f32 v38, v92, v93
    v_cvt_pk_bf16_f32 v39, v94, v95
    s_cmp_ge_u32 s65, 14
    s_cbranch_scc1 P3_NOST1
    buffer_store_dwordx4 v[32:35], v4, s[16:19], s74 offen offset:2048 sc1
    buffer_store_dwordx4 v[36:39], v4, s[16:19], s74 offen offset:3072 sc1
P3_NOST1:
    v_pk_mul_f32 v[112:113], v[96:97], v[96:97]
    v_pk_mul_f32 v[114:115], v[98:99], v[98:99]
    v_pk_mul_f32 v[116:117], v[100:101], v[100:101]
    v_pk_mul_f32 v[118:119], v[102:103], v[102:103]
    v_pk_mul_f32 v[120:121], v[104:105], v[104:105]
    v_pk_mul_f32 v[122:123], v[106:107], v[106:107]
    v_pk_mul_f32 v[124:125], v[108:109], v[108:109]
    v_pk_mul_f32 v[126:127], v[110:111], v[110:111]
    v_pk_fma_f32 v[112:113], v[112:113], v[14:15], v[14:15] op_sel:[0,0,1] op_sel_hi:[1,0,1]
    v_pk_fma_f32 v[114:115], v[114:115], v[14:15], v[14:15] op_sel:[0,0,1] op_sel_hi:[1,0,1]
    v_pk_fma_f32 v[116:117], v[116:117], v[14:15], v[14:15] op_sel:[0,0,1] op_sel_hi:[1,0,1]
    v_pk_fma_f32 v[118:119], v[118:119], v[14:15], v[14:15] op_sel:[0,0,1] op_sel_hi:[1,0,1]
    v_pk_fma_f32 v[120:121], v[120:121], v[14:15], v[14:15] op_sel:[0,0,1] op_sel_hi:[1,0,1]
    v_pk_fma_f32 v[122:123], v[122:123], v[14:15], v[14:15] op_sel:[0,0,1] op_sel_hi:[1,0,1]
    v_pk_fma_f32 v[124:125], v[124:125], v[14:15], v[14:15] op_sel:[0,0,1] op_sel_hi:[1,0,1]
    v_pk_fma_f32 v[126:127], v[126:127], v[14:15], v[14:15] op_sel:[0,0,1] op_sel_hi:[1,0,1]
    v_pk_mul_f32 v[112:113], v[112:113], v[96:97]
    v_pk_mul_f32 v[114:115], v[114:115], v[98:99]
    v_pk_mul_f32 v[116:117], v[116:117], v[100:101]
    v_pk_mul_f32 v[118:119], v[118:119], v[102:103]
    v_pk_mul_f32 v[120:121], v[120:121], v[104:105]
    v_pk_mul_f32 v[122:123], v[122:123], v[106:107]
    v_pk_mul_f32 v[124:125], v[124:125], v[108:109]
    v_pk_mul_f32 v[126:127], v[126:127], v[110:111]
    v_exp_f32 v112, v112
    v_exp_f32 v113, v113
    v_exp_f32 v114, v114
    v_exp_f32 v115, v115
    v_exp_f32 v116, v116
    v_exp_f32 v117, v117
    v_exp_f32 v118, v118
    v_exp_f32 v119, v119
    v_exp_f32 v120, v120
    v_exp_f32 v121, v121
    v_exp_f32 v122, v122
    v_exp_f32 v123, v123
    v_exp_f32 v124, v124
    v_exp_f32 v125, v125
    v_exp_f32 v126, v126
    v_exp_f32 v127, v127
    v_pk_fma_f32 v[112:113], v[112:113], v[16:17], v[16:17] op_sel_hi:[1,0,0]
    v_pk_fma_f32 v[114:115], v[114:115], v[16:17], v[16:17] op_sel_hi:[1,0,0]
    v_pk_fma_f32 v[116:117], v[116:117], v[16:17], v[16:17] op_sel_hi:[1,0,0]
    v_pk_fma_f32 v[118:119], v[118:119], v[16:17], v[16:17] op_sel_hi:[1,0,0]
    v_pk_fma_f32 v[120:121], v[120:121], v[16:17], v[16:17] op_sel_hi:[1,0,0]
    v_pk_fma_f32 v[122:123], v[122:123], v[16:17], v[16:17] op_sel_hi:[1,0,0]
    v_pk_fma_f32 v[124:125], v[124:125], v[16:17], v[16:17] op_sel_hi:[1,0,0]
    v_pk_fma_f32 v[126:127], v[126:127], v[16:17], v[16:17] op_sel_hi:[1,0,0]
    v_rcp_f32 v112, v112
    v_rcp_f32 v113, v113
    v_rcp_f32 v114, v114
    v_rcp_f32 v115, v115
    v_rcp_f32 v116, v116
    v_rcp_f32 v117, v117
    v_rcp_f32 v118, v118
    v_rcp_f32 v119, v119
    v_rcp_f32 v120, v120
    v_rcp_f32 v121, v121
    v_rcp_f32 v122, v122
    v_rcp_f32 v123, v123
    v_rcp_f32 v124, v124
    v_rcp_f32 v125, v125
    v_rcp_f32 v126, v126
    v_rcp_f32 v127, v127
    v_pk_mul_f32 v[96:97], v[96:97], v[112:113]
    v_pk_mul_f32 v[98:99], v[98:99], v[114:115]
    v_pk_mul_f32 v[100:101], v[100:101], v[116:117]
    v_pk_mul_f32 v[102:103], v[102:103], v[118:119]
    v_pk_mul_f32 v[104:105], v[104:105], v[120:121]
    v_pk_mul_f32 v[106:107], v[106:107], v[122:123]
    v_pk_mul_f32 v[108:109], v[108:109], v[124:125]
    v_pk_mul_f32 v[110:111], v[110:111], v[126:127]
    v_cvt_pk_bf16_f32 v44, v96, v97
    v_cvt_pk_bf16_f32 v45, v98, v99
    v_cvt_pk_bf16_f32 v46, v100, v101
    v_cvt_pk_bf16_f32 v47, v102, v103
    v_cvt_pk_bf16_f32 v48, v104, v105
    v_cvt_pk_bf16_f32 v49, v106, v107
    v_cvt_pk_bf16_f32 v50, v108, v109
    v_cvt_pk_bf16_f32 v51, v110, v111
    s_cmp_ge_u32 s65, 14
    s_cbranch_scc1 P3_NOST2
    s_add_u32 s74, s74, 4096
    buffer_store_dwordx4 v[44:47], v4, s[16:19], s74 offen offset:0 sc1
    buffer_store_dwordx4 v[48:51], v4, s[16:19], s74 offen offset:1024 sc1
P3_NOST2:
    s_add_u32 s8, s58, 20971520
    s_addc_u32 s9, s59, 0
    s_mov_b32 s10, 5636096
    s_mov_b32 s11, 0x20000
    s_mov_b32 s24, s52
    s_mov_b32 s25, s53
    s_mov_b32 s26, 1024
    s_mov_b32 s27, 0x20000
    s_mov_b32 s28, s54
    s_mov_b32 s29, s55
    s_mov_b32 s30, 2097152
    s_mov_b32 s31, 0x20000
    s_lshl_b32 s73, s35, 6
    s_lshl_b32 s70, s65, 2
    s_add_u32 s73, s73, s70
    s_add_u32 s73, s73, 4730880
    s_lshl_b32 s70, s66, 13
    s_add_u32 s70, s70, 65536
    v_add_u32 v14, s70, v12
    v_add_u32 v15, s70, v13
    v_lshlrev_b32 v16, 10, v1
    v_lshl_add_u32 v16, v2, 4, v16
    v_lshlrev_b32 v17, 3, v2
    s_mov_b32 s78, 983055
    s_cmp_eq_u32 s66, 1
    s_cselect_b32 s78, 16253176, s78
    s_cmp_eq_u32 s66, 2
    s_cselect_b32 s78, 125831040, s78
    s_cmp_eq_u32 s66, 3
    s_cselect_b32 s78, 2013296640, s78
    s_mov_b32 s79, 0
    s_lshl_b32 s75, s62, 7
    s_add_u32 s75, s75, 4730880
    v_lshlrev_b32 v60, 2, v0
    v_and_b32 v60, 127, v60
    s_waitcnt vmcnt(6)
    s_cmp_lt_u32 s65, 14
    s_cbranch_scc1 P4_CI
    s_waitcnt vmcnt(0)
P4_CI:
    v_lshlrev_b32 v192, 16, v208
    v_and_b32 v193, 0xffff0000, v208
    v_lshlrev_b32 v52, 16, v216
    v_and_b32 v53, 0xffff0000, v216
    v_pk_add_f32 v[192:193], v[192:193], v[52:53]
    v_lshlrev_b32 v194, 16, v209
    v_and_b32 v195, 0xffff0000, v209
    v_lshlrev_b32 v52, 16, v217
    v_and_b32 v53, 0xffff0000, v217
    v_pk_add_f32 v[194:195], v[194:195], v[52:53]
    v_lshlrev_b32 v196, 16, v210
    v_and_b32 v197, 0xffff0000, v210
    v_lshlrev_b32 v52, 16, v218
    v_and_b32 v53, 0xffff0000, v218
    v_pk_add_f32 v[196:197], v[196:197], v[52:53]
    v_lshlrev_b32 v198, 16, v211
    v_and_b32 v199, 0xffff0000, v211
    v_lshlrev_b32 v52, 16, v219
    v_and_b32 v53, 0xffff0000, v219
    v_pk_add_f32 v[198:199], v[198:199], v[52:53]
    v_lshlrev_b32 v200, 16, v212
    v_and_b32 v201, 0xffff0000, v212
    v_lshlrev_b32 v52, 16, v220
    v_and_b32 v53, 0xffff0000, v220
    v_pk_add_f32 v[200:201], v[200:201], v[52:53]
    v_lshlrev_b32 v202, 16, v213
    v_and_b32 v203, 0xffff0000, v213
    v_lshlrev_b32 v52, 16, v221
    v_and_b32 v53, 0xffff0000, v221
    v_pk_add_f32 v[202:203], v[202:203], v[52:53]
    v_lshlrev_b32 v204, 16, v214
    v_and_b32 v205, 0xffff0000, v214
    v_lshlrev_b32 v52, 16, v222
    v_and_b32 v53, 0xffff0000, v222
    v_pk_add_f32 v[204:205], v[204:205], v[52:53]
    v_lshlrev_b32 v206, 16, v215
    v_and_b32 v207, 0xffff0000, v215
    v_lshlrev_b32 v52, 16, v223
    v_and_b32 v53, 0xffff0000, v223
    v_pk_add_f32 v[206:207], v[206:207], v[52:53]
    s_lshl_b32 s3, s66, 14
    v_add_u32 v56, s3, v4
    v_xor_b32 v57, 16384, v56
    v_xor_b32 v58, 32768, v56
    v_xor_b32 v59, 49152, v56
    s_waitcnt vmcnt(0)
    s_cmp_eq_u32 s65, 15
    s_cbranch_scc1 P3_NOFL
    v_mov_b32 v62, s69
    v_mov_b32 v63, 0
    s_mov_b64 exec, 1
    s_cmp_eq_u32 s4, 1
    s_cbranch_scc1 HS33
    buffer_store_dword v62, v63, s[16:19], s73 offen sc1
    s_branch HE34
HS33:
    buffer_store_dword v62, v63, s[16:19], s73 offen
HE34:
    s_mov_b64 exec, -1
P3_NOFL:
    s_add_u32 s72, s76, 327680
    buffer_load_dwordx4 v[20:23], v10, s[12:15], s72 offen
    s_add_u32 s72, s76, 335872
    buffer_load_dwordx4 v[24:27], v10, s[12:15], s72 offen
    s_add_u32 s72, s76, 344064
    buffer_load_dwordx4 v[28:31], v10, s[12:15], s72 offen
    s_add_u32 s72, s76, 352256
    buffer_load_dwordx4 v[32:35], v10, s[12:15], s72 offen
    s_lshl_b32 s73, s63, 7
    s_lshl_b32 s70, s68, 6
    s_add_u32 s73, s73, s70
PL35:
    buffer_load_dword v61, v60, s[16:19], s75 offen sc1
    s_sub_u32 s5, s5, 1
    s_cmp_lt_i32 s5, 0
    s_cbranch_scc1 PE36
    s_waitcnt vmcnt(0)
    v_cmp_ne_u32 vcc, s69, v61
    s_nop 0
    s_and_b64 vcc, vcc, s[78:79]
    s_cbranch_scc1 PL35
PE36:
    s_lshl_b32 s7, s62, 16
    s_lshl_b32 s70, s67, 15
    s_add_u32 s7, s7, s70
    s_add_u32 s7, s7, s73
    s_mul_i32 s74, s62, 176128
    s_mul_i32 s70, s66, 22528
    s_add_u32 s74, s74, s70
    s_mul_i32 s70, s67, 88064
    s_add_u32 s75, s74, 88064
    s_sub_u32 s75, s75, s70
    s_add_u32 s74, s74, s70
    s_cmp_eq_u32 s66, 3
    s_cselect_b32 s32, 20, 99
    s_mov_b32 s33, s6
    s_lshl_b32 s73, s33, 10
    s_cmp_ge_u32 s33, s32
    s_cselect_b32 s73, 0x40000000, s73
    s_add_u32 s70, s74, s73
    buffer_load_dwordx4 v[64:67], v4, s[8:11], s70 offen sc1
    s_add_u32 s70, s75, s73
    buffer_load_dwordx4 v[68:71], v4, s[8:11], s70 offen sc1
    s_add_u32 s33, s33, 1
    s_cmp_eq_u32 s33, 22
    s_cselect_b32 s33, 0, s33
    s_lshl_b32 s73, s33, 10
    s_cmp_ge_u32 s33, s32
    s_cselect_b32 s73, 0x40000000, s73
    s_add_u32 s70, s74, s73
    buffer_load_dwordx4 v[72:75], v4, s[8:11], s70 offen sc1
    s_add_u32 s70, s75, s73
    buffer_load_dwordx4 v[76:79], v4, s[8:11], s70 offen sc1
    s_add_u32 s33, s33, 1
    s_cmp_eq_u32 s33, 22
    s_cselect_b32 s33, 0, s33
    s_lshl_b32 s73, s33, 10
    s_cmp_ge_u32 s33, s32
    s_cselect_b32 s73, 0x40000000, s73
    s_add_u32 s70, s74, s73
    buffer_load_dwordx4 v[80:83], v4, s[8:11], s70 offen sc1
    s_add_u32 s70, s75, s73
    buffer_load_dwordx4 v[84:87], v4, s[8:11], s70 offen sc1
    s_add_u32 s33, s33, 1
    s_cmp_eq_u32 s33, 22
    s_cselect_b32 s33, 0, s33
    s_lshl_b32 s73, s33, 10
    s_cmp_ge_u32 s33, s32
    s_cselect_b32 s73, 0x40000000, s73
    s_add_u32 s70, s74, s73
    buffer_load_dwordx4 v[88:91], v4, s[8:11], s70 offen sc1
    s_add_u32 s70, s75, s73
    buffer_load_dwordx4 v[92:95], v4, s[8:11], s70 offen sc1
    s_add_u32 s33, s33, 1
    s_cmp_eq_u32 s33, 22
    s_cselect_b32 s33, 0, s33
    s_lshl_b32 s73, s33, 10
    s_cmp_ge_u32 s33, s32
    s_cselect_b32 s73, 0x40000000, s73
    s_add_u32 s70, s74, s73
    buffer_load_dwordx4 v[96:99], v4, s[8:11], s70 offen sc1
    s_add_u32 s70, s75, s73
    buffer_load_dwordx4 v[100:103], v4, s[8:11], s70 offen sc1
    s_add_u32 s33, s33, 1
    s_cmp_eq_u32 s33, 22
    s_cselect_b32 s33, 0, s33
    s_lshl_b32 s73, s33, 10
    s_cmp_ge_u32 s33, s32
    s_cselect_b32 s73, 0x40000000, s73
    s_add_u32 s70, s74, s73
    buffer_load_dwordx4 v[104:107], v4, s[8:11], s70 offen sc1
    s_add_u32 s70, s75, s73
    buffer_load_dwordx4 v[108:111], v4, s[8:11], s70 offen sc1
    s_add_u32 s33, s33, 1
    s_cmp_eq_u32 s33, 22
    s_cselect_b32 s33, 0, s33
    s_barrier
    ds_read_b64_tr_b16 v[36:37], v12 offset:0
    ds_read_b64_tr_b16 v[38:39], v12 offset:1024
    ds_read_b64_tr_b16 v[40:41], v13 offset:0
    ds_read_b64_tr_b16 v[42:43], v13 offset:1024
    ds_read_b64_tr_b16 v[44:45], v12 offset:2048
    ds_read_b64_tr_b16 v[46:47], v12 offset:3072
    ds_read_b64_tr_b16 v[48:49], v13 offset:2048
    ds_read_b64_tr_b16 v[50:51], v13 offset:3072
    s_waitcnt vmcnt(10) lgkmcnt(4)
    v_mfma_f32_32x32x16_bf16 v[208:223], v[36:39], v[68:71], 0
    s_lshl_b32 s73, s33, 10
    s_cmp_ge_u32 s33, s32
    s_cselect_b32 s73, 0x40000000, s73
    s_add_u32 s70, s74, s73
    buffer_load_dwordx4 v[112:115], v4, s[8:11], s70 offen sc1
    v_mfma_f32_32x32x16_bf16 v[224:239], v[40:43], v[64:67], 0
    s_add_u32 s70, s75, s73
    buffer_load_dwordx4 v[116:119], v4, s[8:11], s70 offen sc1
    s_add_u32 s33, s33, 1
    s_cmp_eq_u32 s33, 22
    s_cselect_b32 s33, 0, s33
    v_mfma_f32_32x32x16_bf16 v[240:255], v[40:43], v[68:71], 0
    v_mfma_f32_32x32x16_bf16 v[192:207], v[36:39], v[64:67], v[192:207]
    ds_read_b64_tr_b16 v[36:37], v12 offset:4096
    ds_read_b64_tr_b16 v[38:39], v12 offset:5120
    ds_read_b64_tr_b16 v[40:41], v13 offset:4096
    ds_read_b64_tr_b16 v[42:43], v13 offset:5120
    s_waitcnt vmcnt(10) lgkmcnt(4)
    v_mfma_f32_32x32x16_bf16 v[208:223], v[44:47], v[76:79], v[208:223]
    s_lshl_b32 s73, s33, 10
    s_cmp_ge_u32 s33, s32
    s_cselect_b32 s73, 0x40000000, s73
    s_add_u32 s70, s74, s73
    buffer_load_dwordx4 v[120:123], v4, s[8:11], s70 offen sc1
    v_mfma_f32_32x32x16_bf16 v[224:239], v[48:51], v[72:75], v[224:239]
    s_add_u32 s70, s75, s73
    buffer_load_dwordx4 v[124:127], v4, s[8:11], s70 offen sc1
    s_add_u32 s33, s33, 1
    s_cmp_eq_u32 s33, 22
    s_cselect_b32 s33, 0, s33
    v_mfma_f32_32x32x16_bf16 v[240:255], v[48:51], v[76:79], v[240:255]
    v_mfma_f32_32x32x16_bf16 v[192:207], v[44:47], v[72:75], v[192:207]
    ds_read_b64_tr_b16 v[44:45], v12 offset:6144
    ds_read_b64_tr_b16 v[46:47], v12 offset:7168
    ds_read_b64_tr_b16 v[48:49], v13 offset:6144
    ds_read_b64_tr_b16 v[50:51], v13 offset:7168
    s_waitcnt vmcnt(10) lgkmcnt(4)
    v_mfma_f32_32x32x16_bf16 v[208:223], v[36:39], v[84:87], v[208:223]
    s_lshl_b32 s73, s33, 10
    s_cmp_ge_u32 s33, s32
    s_cselect_b32 s73, 0x40000000, s73
    s_add_u32 s70, s74, s73
    buffer_load_dwordx4 v[128:131], v4, s[8:11], s70 offen sc1
    v_mfma_f32_32x32x16_bf16 v[224:239], v[40:43], v[80:83], v[224:239]
    s_add_u32 s70, s75, s73
    buffer_load_dwordx4 v[132:135], v4, s[8:11], s70 offen sc1
    s_add_u32 s33, s33, 1
    s_cmp_eq_u32 s33, 22
    s_cselect_b32 s33, 0, s33
    v_mfma_f32_32x32x16_bf16 v[240:255], v[40:43], v[84:87], v[240:255]
    v_mfma_f32_32x32x16_bf16 v[192:207], v[36:39], v[80:83], v[192:207]
    ds_read_b64_tr_b16 v[36:37], v12 offset:8192
    ds_read_b64_tr_b16 v[38:39], v12 offset:9216
    ds_read_b64_tr_b16 v[40:41], v13 offset:8192
    ds_read_b64_tr_b16 v[42:43], v13 offset:9216
    s_waitcnt vmcnt(10) lgkmcnt(4)
    v_mfma_f32_32x32x16_bf16 v[208:223], v[44:47], v[92:95], v[208:223]
    s_lshl_b32 s73, s33, 10
    s_cmp_ge_u32 s33, s32
    s_cselect_b32 s73, 0x40000000, s73
    s_add_u32 s70, s74, s73
    buffer_load_dwordx4 v[136:139], v4, s[8:11], s70 offen sc1
    v_mfma_f32_32x32x16_bf16 v[224:239], v[48:51], v[88:91], v[224:239]
    s_add_u32 s70, s75, s73
    buffer_load_dwordx4 v[140:143], v4, s[8:11], s70 offen sc1
    s_add_u32 s33, s33, 1
    s_cmp_eq_u32 s33, 22
    s_cselect_b32 s33, 0, s33
    v_mfma_f32_32x32x16_bf16 v[240:255], v[48:51], v[92:95], v[240:255]
    v_mfma_f32_32x32x16_bf16 v[192:207], v[44:47], v[88:91], v[192:207]
    ds_read_b64_tr_b16 v[44:45], v12 offset:10240
    ds_read_b64_tr_b16 v[46:47], v12 offset:11264
    ds_read_b64_tr_b16 v[48:49], v13 offset:10240
    ds_read_b64_tr_b16 v[50:51], v13 offset:11264
    s_waitcnt vmcnt(10) lgkmcnt(4)
    v_mfma_f32_32x32x16_bf16 v[208:223], v[36:39], v[100:103], v[208:223]
    s_lshl_b32 s73, s33, 10
    s_cmp_ge_u32 s33, s32
    s_cselect_b32 s73, 0x40000000, s73
    s_add_u32 s70, s74, s73
    buffer_load_dwordx4 v[144:147], v4, s[8:11], s70 offen sc1
    v_mfma_f32_32x32x16_bf16 v[224:239], v[40:43], v[96:99], v[224:239]
    s_add_u32 s70, s75, s73
    buffer_load_dwordx4 v[148:151], v4, s[8:11], s70 offen sc1
    s_add_u32 s33, s33, 1
    s_cmp_eq_u32 s33, 22
    s_cselect_b32 s33, 0, s33
    v_mfma_f32_32x32x16_bf16 v[240:255], v[40:43], v[100:103], v[240:255]
    v_mfma_f32_32x32x16_bf16 v[192:207], v[36:39], v[96:99], v[192:207]
    ds_read_b64_tr_b16 v[36:37], v12 offset:12288
    ds_read_b64_tr_b16 v[38:39], v12 offset:13312
    ds_read_b64_tr_b16 v[40:41], v13 offset:12288
    ds_read_b64_tr_b16 v[42:43], v13 offset:13312
    s_waitcnt vmcnt(10) lgkmcnt(4)
    v_mfma_f32_32x32x16_bf16 v[208:223], v[44:47], v[108:111], v[208:223]
    s_lshl_b32 s73, s33, 10
    s_cmp_ge_u32 s33, s32
    s_cselect_b32 s73, 0x40000000, s73
    s_add_u32 s70, s74, s73
    buffer_load_dwordx4 v[152:155], v4, s[8:11], s70 offen sc1
    v_mfma_f32_32x32x16_bf16 v[224:239], v[48:51], v[104:107], v[224:239]
    s_add_u32 s70, s75, s73
    buffer_load_dwordx4 v[156:159], v4, s[8:11], s70 offen sc1
    s_add_u32 s33, s33, 1
    s_cmp_eq_u32 s33, 22
    s_cselect_b32 s33, 0, s33
    v_mfma_f32_32x32x16_bf16 v[240:255], v[48:51], v[108:111], v[240:255]
    v_mfma_f32_32x32x16_bf16 v[192:207], v[44:47], v[104:107], v[192:207]
    ds_read_b64_tr_b16 v[44:45], v12 offset:14336
    ds_read_b64_tr_b16 v[46:47], v12 offset:15360
    ds_read_b64_tr_b16 v[48:49], v13 offset:14336
    ds_read_b64_tr_b16 v[50:51], v13 offset:15360
    s_waitcnt vmcnt(10) lgkmcnt(4)
    v_mfma_f32_32x32x16_bf16 v[208:223], v[36:39], v[116:119], v[208:223]
    s_lshl_b32 s73, s33, 10
    s_cmp_ge_u32 s33, s32
    s_cselect_b32 s73, 0x40000000, s73
    s_add_u32 s70, s74, s73
    buffer_load_dwordx4 v[160:163], v4, s[8:11], s70 offen sc1
    v_mfma_f32_32x32x16_bf16 v[224:239], v[40:43], v[112:115], v[224:239]
    s_add_u32 s70, s75, s73
    buffer_load_dwordx4 v[164:167], v4, s[8:11], s70 offen sc1
    s_add_u32 s33, s33, 1
    s_cmp_eq_u32 s33, 22
    s_cselect_b32 s33, 0, s33
    v_mfma_f32_32x32x16_bf16 v[240:255], v[40:43], v[116:119], v[240:255]
    v_mfma_f32_32x32x16_bf16 v[192:207], v[36:39], v[112:115], v[192:207]
    ds_read_b64_tr_b16 v[36:37], v14 offset:0
    ds_read_b64_tr_b16 v[38:39], v14 offset:1024
    ds_read_b64_tr_b16 v[40:41], v15 offset:0
    ds_read_b64_tr_b16 v[42:43], v15 offset:1024
    s_waitcnt vmcnt(10) lgkmcnt(4)
    v_mfma_f32_32x32x16_bf16 v[208:223], v[44:47], v[124:127], v[208:223]
    s_lshl_b32 s73, s33, 10
    s_cmp_ge_u32 s33, s32
    s_cselect_b32 s73, 0x40000000, s73
    s_add_u32 s70, s74, s73
    buffer_load_dwordx4 v[168:171], v4, s[8:11], s70 offen sc1
    v_mfma_f32_32x32x16_bf16 v[224:239], v[48:51], v[120:123], v[224:239]
    s_add_u32 s70, s75, s73
    buffer_load_dwordx4 v[172:175], v4, s[8:11], s70 offen sc1
    s_add_u32 s33, s33, 1
    s_cmp_eq_u32 s33, 22
    s_cselect_b32 s33, 0, s33
    v_mfma_f32_32x32x16_bf16 v[240:255], v[48:51], v[124:127], v[240:255]
    v_mfma_f32_32x32x16_bf16 v[192:207], v[44:47], v[120:123], v[192:207]
    ds_write_b128 v56, v[20:23] offset:0
    ds_read_b64_tr_b16 v[44:45], v14 offset:2048
    ds_read_b64_tr_b16 v[46:47], v14 offset:3072
    ds_read_b64_tr_b16 v[48:49], v15 offset:2048
    ds_read_b64_tr_b16 v[50:51], v15 offset:3072
    s_waitcnt vmcnt(10) lgkmcnt(4)
    v_mfma_f32_32x32x16_bf16 v[208:223], v[36:39], v[132:135], v[208:223]
    s_lshl_b32 s73, s33, 10
    s_cmp_ge_u32 s33, s32
    s_cselect_b32 s73, 0x40000000, s73
    s_add_u32 s70, s74, s73
    buffer_load_dwordx4 v[176:179], v4, s[8:11], s70 offen sc1
    v_mfma_f32_32x32x16_bf16 v[224:239], v[40:43], v[128:131], v[224:239]
    s_add_u32 s70, s75, s73
    buffer_load_dwordx4 v[180:183], v4, s[8:11], s70 offen sc1
    s_add_u32 s33, s33, 1
    s_cmp_eq_u32 s33, 22
    s_cselect_b32 s33, 0, s33
    v_mfma_f32_32x32x16_bf16 v[240:255], v[40:43], v[132:135], v[240:255]
    v_mfma_f32_32x32x16_bf16 v[192:207], v[36:39], v[128:131], v[192:207]
    ds_read_b64_tr_b16 v[36:37], v14 offset:4096
    ds_read_b64_tr_b16 v[38:39], v14 offset:5120
    ds_read_b64_tr_b16 v[40:41], v15 offset:4096
    ds_read_b64_tr_b16 v[42:43], v15 offset:5120
    s_waitcnt vmcnt(10) lgkmcnt(4)
    v_mfma_f32_32x32x16_bf16 v[208:223], v[44:47], v[140:143], v[208:223]
    s_lshl_b32 s73, s33, 10
    s_cmp_ge_u32 s33, s32
    s_cselect_b32 s73, 0x40000000, s73
    s_add_u32 s70, s74, s73
    buffer_load_dwordx4 v[184:187], v4, s[8:11], s70 offen sc1
    v_mfma_f32_32x32x16_bf16 v[224:239], v[48:51], v[136:139], v[224:239]
    s_add_u32 s70, s75, s73
    buffer_load_dwordx4 v[188:191], v4, s[8:11], s70 offen sc1
    s_add_u32 s33, s33, 1
    s_cmp_eq_u32 s33, 22
    s_cselect_b32 s33, 0, s33
    v_mfma_f32_32x32x16_bf16 v[240:255], v[48:51], v[140:143], v[240:255]
    v_mfma_f32_32x32x16_bf16 v[192:207], v[44:47], v[136:139], v[192:207]
    ds_write_b128 v56, v[24:27] offset:1024
    ds_read_b64_tr_b16 v[44:45], v14 offset:6144
    ds_read_b64_tr_b16 v[46:47], v14 offset:7168
    ds_read_b64_tr_b16 v[48:49], v15 offset:6144
    ds_read_b64_tr_b16 v[50:51], v15 offset:7168
    s_waitcnt vmcnt(10) lgkmcnt(4)
    v_mfma_f32_32x32x16_bf16 v[208:223], v[36:39], v[148:151], v[208:223]
    s_lshl_b32 s73, s33, 10
    s_cmp_ge_u32 s33, s32
    s_cselect_b32 s73, 0x40000000, s73
    s_add_u32 s70, s74, s73
    buffer_load_dwordx4 v[64:67], v4, s[8:11], s70 offen sc1
    v_mfma_f32_32x32x16_bf16 v[224:239], v[40:43], v[144:147], v[224:239]
    s_add_u32 s70, s75, s73
    buffer_load_dwordx4 v[68:71], v4, s[8:11], s70 offen sc1
    s_add_u32 s33, s33, 1
    s_cmp_eq_u32 s33, 22
    s_cselect_b32 s33, 0, s33
    v_mfma_f32_32x32x16_bf16 v[240:255], v[40:43], v[148:151], v[240:255]
    v_mfma_f32_32x32x16_bf16 v[192:207], v[36:39], v[144:147], v[192:207]
    ds_read_b64_tr_b16 v[36:37], v14 offset:8192
    ds_read_b64_tr_b16 v[38:39], v14 offset:9216
    ds_read_b64_tr_b16 v[40:41], v15 offset:8192
    ds_read_b64_tr_b16 v[42:43], v15 offset:9216
    s_waitcnt vmcnt(10) lgkmcnt(4)
    v_mfma_f32_32x32x16_bf16 v[208:223], v[44:47], v[156:159], v[208:223]
    s_lshl_b32 s73, s33, 10
    s_cmp_ge_u32 s33, s32
    s_cselect_b32 s73, 0x40000000, s73
    s_add_u32 s70, s74, s73
    buffer_load_dwordx4 v[72:75], v4, s[8:11], s70 offen sc1
    v_mfma_f32_32x32x16_bf16 v[224:239], v[48:51], v[152:155], v[224:239]
    s_add_u32 s70, s75, s73
    buffer_load_dwordx4 v[76:79], v4, s[8:11], s70 offen sc1
    s_add_u32 s33, s33, 1
    s_cmp_eq_u32 s33, 22
    s_cselect_b32 s33, 0, s33
    v_mfma_f32_32x32x16_bf16 v[240:255], v[48:51], v[156:159], v[240:255]
    v_mfma_f32_32x32x16_bf16 v[192:207], v[44:47], v[152:155], v[192:207]
    ds_write_b128 v56, v[28:31] offset:2048
    ds_read_b64_tr_b16 v[44:45], v14 offset:10240
    ds_read_b64_tr_b16 v[46:47], v14 offset:11264
    ds_read_b64_tr_b16 v[48:49], v15 offset:10240
    ds_read_b64_tr_b16 v[50:51], v15 offset:11264
    s_waitcnt vmcnt(10) lgkmcnt(4)
    v_mfma_f32_32x32x16_bf16 v[208:223], v[36:39], v[164:167], v[208:223]
    s_lshl_b32 s73, s33, 10
    s_cmp_ge_u32 s33, s32
    s_cselect_b32 s73, 0x40000000, s73
    s_add_u32 s70, s74, s73
    buffer_load_dwordx4 v[80:83], v4, s[8:11], s70 offen sc1
    v_mfma_f32_32x32x16_bf16 v[224:239], v[40:43], v[160:163], v[224:239]
    s_add_u32 s70, s75, s73
    buffer_load_dwordx4 v[84:87], v4, s[8:11], s70 offen sc1
    s_add_u32 s33, s33, 1
    s_cmp_eq_u32 s33, 22
    s_cselect_b32 s33, 0, s33
    v_mfma_f32_32x32x16_bf16 v[240:255], v[40:43], v[164:167], v[240:255]
    v_mfma_f32_32x32x16_bf16 v[192:207], v[36:39], v[160:163], v[192:207]
    ds_read_b64_tr_b16 v[36:37], v14 offset:12288
    ds_read_b64_tr_b16 v[38:39], v14 offset:13312
    ds_read_b64_tr_b16 v[40:41], v15 offset:12288
    ds_read_b64_tr_b16 v[42:43], v15 offset:13312
    s_waitcnt vmcnt(10) lgkmcnt(4)
    v_mfma_f32_32x32x16_bf16 v[208:223], v[44:47], v[172:175], v[208:223]
    s_lshl_b32 s73, s33, 10
    s_cmp_ge_u32 s33, s32
    s_cselect_b32 s73, 0x40000000, s73
    s_add_u32 s70, s74, s73
    buffer_load_dwordx4 v[88:91], v4, s[8:11], s70 offen sc1
    v_mfma_f32_32x32x16_bf16 v[224:239], v[48:51], v[168:171], v[224:239]
    s_add_u32 s70, s75, s73
    buffer_load_dwordx4 v[92:95], v4, s[8:11], s70 offen sc1
    s_add_u32 s33, s33, 1
    s_cmp_eq_u32 s33, 22
    s_cselect_b32 s33, 0, s33
    v_mfma_f32_32x32x16_bf16 v[240:255], v[48:51], v[172:175], v[240:255]
    v_mfma_f32_32x32x16_bf16 v[192:207], v[44:47], v[168:171], v[192:207]
    ds_write_b128 v56, v[32:35] offset:3072
    ds_read_b64_tr_b16 v[44:45], v14 offset:14336
    ds_read_b64_tr_b16 v[46:47], v14 offset:15360
    ds_read_b64_tr_b16 v[48:49], v15 offset:14336
    ds_read_b64_tr_b16 v[50:51], v15 offset:15360
    s_waitcnt vmcnt(10) lgkmcnt(4)
    v_mfma_f32_32x32x16_bf16 v[208:223], v[36:39], v[180:183], v[208:223]
    s_lshl_b32 s73, s33, 10
    s_cmp_ge_u32 s33, s32
    s_cselect_b32 s73, 0x40000000, s73
    s_add_u32 s70, s74, s73
    buffer_load_dwordx4 v[96:99], v4, s[8:11], s70 offen sc1
    v_mfma_f32_32x32x16_bf16 v[224:239], v[40:43], v[176:179], v[224:239]
    s_add_u32 s70, s75, s73
    buffer_load_dwordx4 v[100:103], v4, s[8:11], s70 offen sc1
    s_add_u32 s33, s33, 1
    s_cmp_eq_u32 s33, 22
    s_cselect_b32 s33, 0, s33
    v_mfma_f32_32x32x16_bf16 v[240:255], v[40:43], v[180:183], v[240:255]
    v_mfma_f32_32x32x16_bf16 v[192:207], v[36:39], v[176:179], v[192:207]
    ds_read_b64_tr_b16 v[36:37], v14 offset:16384
    ds_read_b64_tr_b16 v[38:39], v14 offset:17408
    ds_read_b64_tr_b16 v[40:41], v15 offset:16384
    ds_read_b64_tr_b16 v[42:43], v15 offset:17408
    s_waitcnt vmcnt(10) lgkmcnt(4)
    v_mfma_f32_32x32x16_bf16 v[208:223], v[44:47], v[188:191], v[208:223]
    s_lshl_b32 s73, s33, 10
    s_cmp_ge_u32 s33, s32
    s_cselect_b32 s73, 0x40000000, s73
    s_add_u32 s70, s74, s73
    buffer_load_dwordx4 v[104:107], v4, s[8:11], s70 offen sc1
    v_mfma_f32_32x32x16_bf16 v[224:239], v[48:51], v[184:187], v[224:239]
    s_add_u32 s70, s75, s73
    buffer_load_dwordx4 v[108:111], v4, s[8:11], s70 offen sc1
    s_add_u32 s33, s33, 1
    s_cmp_eq_u32 s33, 22
    s_cselect_b32 s33, 0, s33
    v_mfma_f32_32x32x16_bf16 v[240:255], v[48:51], v[188:191], v[240:255]
    v_mfma_f32_32x32x16_bf16 v[192:207], v[44:47], v[184:187], v[192:207]
    ds_read_b64_tr_b16 v[44:45], v14 offset:18432
    ds_read_b64_tr_b16 v[46:47], v14 offset:19456
    ds_read_b64_tr_b16 v[48:49], v15 offset:18432
    ds_read_b64_tr_b16 v[50:51], v15 offset:19456
    s_waitcnt vmcnt(10) lgkmcnt(4)
    v_mfma_f32_32x32x16_bf16 v[208:223], v[36:39], v[68:71], v[208:223]
    v_mfma_f32_32x32x16_bf16 v[224:239], v[40:43], v[64:67], v[224:239]
    v_mfma_f32_32x32x16_bf16 v[240:255], v[40:43], v[68:71], v[240:255]
    v_mfma_f32_32x32x16_bf16 v[192:207], v[36:39], v[64:67], v[192:207]
    ds_read_b64_tr_b16 v[36:37], v14 offset:20480
    ds_read_b64_tr_b16 v[38:39], v14 offset:21504
    ds_read_b64_tr_b16 v[40:41], v15 offset:20480
    ds_read_b64_tr_b16 v[42:43], v15 offset:21504
    s_waitcnt vmcnt(8) lgkmcnt(4)
    v_mfma_f32_32x32x16_bf16 v[208:223], v[44:47], v[76:79], v[208:223]
    v_mfma_f32_32x32x16_bf16 v[224:239], v[48:51], v[72:75], v[224:239]
    v_mfma_f32_32x32x16_bf16 v[240:255], v[48:51], v[76:79], v[240:255]
    v_mfma_f32_32x32x16_bf16 v[192:207], v[44:47], v[72:75], v[192:207]
    ds_read_b64_tr_b16 v[44:45], v14 offset:22528
    ds_read_b64_tr_b16 v[46:47], v14 offset:23552
    ds_read_b64_tr_b16 v[48:49], v15 offset:22528
    ds_read_b64_tr_b16 v[50:51], v15 offset:23552
    s_waitcnt vmcnt(6) lgkmcnt(4)
    v_mfma_f32_32x32x16_bf16 v[208:223], v[36:39], v[84:87], v[208:223]
    v_mfma_f32_32x32x16_bf16 v[224:239], v[40:43], v[80:83], v[224:239]
    v_mfma_f32_32x32x16_bf16 v[240:255], v[40:43], v[84:87], v[240:255]
    v_mfma_f32_32x32x16_bf16 v[192:207], v[36:39], v[80:83], v[192:207]
    ds_read_b64_tr_b16 v[36:37], v12 offset:0
    ds_read_b64_tr_b16 v[38:39], v12 offset:1024
    ds_read_b64_tr_b16 v[40:41], v13 offset:0
    ds_read_b64_tr_b16 v[42:43], v13 offset:1024
    s_waitcnt vmcnt(4) lgkmcnt(4)
    v_mfma_f32_32x32x16_bf16 v[208:223], v[44:47], v[92:95], v[208:223]
    v_mfma_f32_32x32x16_bf16 v[224:239], v[48:51], v[88:91], v[224:239]
    v_mfma_f32_32x32x16_bf16 v[240:255], v[48:51], v[92:95], v[240:255]
    v_mfma_f32_32x32x16_bf16 v[192:207], v[44:47], v[88:91], v[192:207]
    ds_read_b64_tr_b16 v[44:45], v12 offset:2048
    ds_read_b64_tr_b16 v[46:47], v12 offset:3072
    ds_read_b64_tr_b16 v[48:49], v13 offset:2048
    ds_read_b64_tr_b16 v[50:51], v13 offset:3072
    s_waitcnt vmcnt(2) lgkmcnt(4)
    v_mfma_f32_32x32x16_bf16 v[208:223], v[36:39], v[100:103], v[208:223]
    v_mfma_f32_32x32x16_bf16 v[224:239], v[40:43], v[96:99], v[224:239]
    v_mfma_f32_32x32x16_bf16 v[240:255], v[40:43], v[100:103], v[240:255]
    v_mfma_f32_32x32x16_bf16 v[192:207], v[36:39], v[96:99], v[192:207]
    s_waitcnt vmcnt(0) lgkmcnt(0)
    v_mfma_f32_32x32x16_bf16 v[208:223], v[44:47], v[108:111], v[208:223]
    v_mfma_f32_32x32x16_bf16 v[224:239], v[48:51], v[104:107], v[224:239]
    v_mfma_f32_32x32x16_bf16 v[240:255], v[48:51], v[108:111], v[240:255]
    v_mfma_f32_32x32x16_bf16 v[192:207], v[44:47], v[104:107], v[192:207]
    s_nop 8
    ds_write_b128 v56, v[208:211] offset:4096
    ds_write_b128 v56, v[212:215] offset:5120
    ds_write_b128 v56, v[216:219] offset:6144
    ds_write_b128 v56, v[220:223] offset:7168
    ds_write_b128 v56, v[224:227] offset:8192
    ds_write_b128 v56, v[228:231] offset:9216
    ds_write_b128 v56, v[232:235] offset:10240
    ds_write_b128 v56, v[236:239] offset:11264
    ds_write_b128 v56, v[240:243] offset:12288
    ds_write_b128 v56, v[244:247] offset:13312
    ds_write_b128 v56, v[248:251] offset:14336
    ds_write_b128 v56, v[252:255] offset:15360
    s_waitcnt lgkmcnt(0)
    s_barrier
    ds_read_b128 v[112:115], v57 offset:4096
    ds_read_b128 v[116:119], v57 offset:5120
    ds_read_b128 v[120:123], v57 offset:6144
    ds_read_b128 v[124:127], v57 offset:7168
    ds_read_b128 v[128:131], v58 offset:8192
    ds_read_b128 v[132:135], v58 offset:9216
    ds_read_b128 v[136:139], v58 offset:10240
    ds_read_b128 v[140:143], v58 offset:11264
    ds_read_b128 v[144:147], v59 offset:12288
    ds_read_b128 v[148:151], v59 offset:13312
    ds_read_b128 v[152:155], v59 offset:14336
    ds_read_b128 v[156:159], v59 offset:15360
    s_waitcnt lgkmcnt(11)
    v_pk_add_f32 v[192:193], v[192:193], v[112:113]
    v_pk_add_f32 v[194:195], v[194:195], v[114:115]
    s_waitcnt lgkmcnt(10)
    v_pk_add_f32 v[196:197], v[196:197], v[116:117]
    v_pk_add_f32 v[198:199], v[198:199], v[118:119]
    s_waitcnt lgkmcnt(9)
    v_pk_add_f32 v[200:201], v[200:201], v[120:121]
    v_pk_add_f32 v[202:203], v[202:203], v[122:123]
    s_waitcnt lgkmcnt(8)
    v_pk_add_f32 v[204:205], v[204:205], v[124:125]
    v_pk_add_f32 v[206:207], v[206:207], v[126:127]
    s_waitcnt lgkmcnt(7)
    v_pk_add_f32 v[192:193], v[192:193], v[128:129]
    v_pk_add_f32 v[194:195], v[194:195], v[130:131]
    s_waitcnt lgkmcnt(6)
    v_pk_add_f32 v[196:197], v[196:197], v[132:133]
    v_pk_add_f32 v[198:199], v[198:199], v[134:135]
    s_waitcnt lgkmcnt(5)
    v_pk_add_f32 v[200:201], v[200:201], v[136:137]
    v_pk_add_f32 v[202:203], v[202:203], v[138:139]
    s_waitcnt lgkmcnt(4)
    v_pk_add_f32 v[204:205], v[204:205], v[140:141]
    v_pk_add_f32 v[206:207], v[206:207], v[142:143]
    s_waitcnt lgkmcnt(3)
    v_pk_add_f32 v[192:193], v[192:193], v[144:145]
    v_pk_add_f32 v[194:195], v[194:195], v[146:147]
    s_waitcnt lgkmcnt(2)
    v_pk_add_f32 v[196:197], v[196:197], v[148:149]
    v_pk_add_f32 v[198:199], v[198:199], v[150:151]
    s_waitcnt lgkmcnt(1)
    v_pk_add_f32 v[200:201], v[200:201], v[152:153]
    v_pk_add_f32 v[202:203], v[202:203], v[154:155]
    s_waitcnt lgkmcnt(0)
    v_pk_add_f32 v[204:205], v[204:205], v[156:157]
    v_pk_add_f32 v[206:207], v[206:207], v[158:159]
    v_cvt_pk_bf16_f32 v48, v192, v193
    v_cvt_pk_bf16_f32 v49, v194, v195
    v_cvt_pk_bf16_f32 v50, v196, v197
    v_cvt_pk_bf16_f32 v51, v198, v199
    v_cvt_pk_bf16_f32 v52, v200, v201
    v_cvt_pk_bf16_f32 v53, v202, v203
    v_cvt_pk_bf16_f32 v54, v204, v205
    v_cvt_pk_bf16_f32 v55, v206, v207
    v_permlane32_swap_b32 v48, v50
    v_permlane32_swap_b32 v49, v51
    buffer_store_dwordx4 v[48:51], v16, s[28:31], s7 offen offset:0
    v_permlane32_swap_b32 v52, v54
    v_permlane32_swap_b32 v53, v55
    buffer_store_dwordx4 v[52:55], v16, s[28:31], s7 offen offset:32
    s_or_b32 s70, s2, s66
    s_cmp_lg_u32 s70, 0
    s_cbranch_scc1 C_NOEP
    v_mov_b32 v60, s69
    v_mov_b32 v61, 0
    s_mov_b32 s70, 4747264
    s_mov_b64 exec, 1
    buffer_store_dword v60, v61, s[16:19], s70 offen sc1
    s_mov_b64 exec, -1
C_NOEP:
    s_endpgm
L_END:
    s_endpgm
.section .rodata,"a"
.p2align 6
.amdhsa_kernel sequential_preLN__linear_kernel_hedgehog__dense_activation_gelu__prompt_kernel
  .amdhsa_next_free_vgpr 256
  .amdhsa_next_free_sgpr 102
  .amdhsa_accum_offset 256
  .amdhsa_group_segment_fixed_size 0
  .amdhsa_kernarg_size 96
  .amdhsa_user_sgpr_count 2
  .amdhsa_user_sgpr_kernarg_segment_ptr 1
  .amdhsa_system_sgpr_workgroup_id_x 1
.end_amdhsa_kernel
```
